```python
import torch

def _softmax(x, axis=-1):
    return torch.softmax(x, dim=axis)
def _gelu(x):
    return torch.nn.functional.gelu(x, approximate="tanh")
def _silu(x):
    return torch.nn.functional.silu(x)
def _sigmoid(x):
    return torch.sigmoid(x)
def _layernorm(x, axis=-1, eps=1e-5):
    m = x.mean(dim=axis, keepdim=True)
    v = x.var(dim=axis, keepdim=True, unbiased=False)
    return (x - m) / torch.sqrt(v + eps)
def _scatter_add(tgt, idx, src, axis=0):
    return tgt.clone().index_add_(axis, idx, src)
def _segment_sum(src, seg, n):
    out = torch.zeros((n,) + src.shape[1:], dtype=src.dtype)
    return out.index_add_(0, seg, src)
def _pad(x, pw):
    flat = tuple(v for pair in reversed(pw) for v in pair)
    return torch.nn.functional.pad(x, flat)

kernel_name = 'concat_heads__gqa_block_cached__gqa_block_cached__near_ridge'

def setup_inputs():

    _w = (lambda a: (lambda t: t.to(torch.bfloat16) if t.is_floating_point() else t)(torch.as_tensor(a)))
    def _A_setup():
        B, Sq, D = 16, 48, 640
        Hq, Hkv, Sk, Dh = 32, 32, 48, 192
        assert Hq % Hkv == 0, (Hq, Hkv)
        return {
            "x": _w((lambda *s: torch.randn(*s, dtype=torch.bfloat16) * 0.8)(B, Sq, D)),
            "k_cache": _w((lambda *s: torch.randn(*s, dtype=torch.bfloat16) * 0.8)(B, Hkv, Sk, Dh)),
            "v_cache": _w((lambda *s: torch.randn(*s, dtype=torch.bfloat16) * 0.05)(B, Hkv, Sk, Dh)),
            "wq": _w((lambda *s: torch.randn(*s, dtype=torch.bfloat16) * 0.8)(D, Hq * Dh) * (D ** -0.5)),
            "wo": _w((lambda *s: torch.randn(*s, dtype=torch.bfloat16) * 0.05)(Hq * Dh, D) * ((Hq * Dh) ** -0.5)),
        }
    _A_in = _A_setup()

    def _B_setup():
        B, Sq, D = 16, 48, 640
        Hq, Hkv, Sk, Dh = 32, 32, 48, 192
        assert Hq % Hkv == 0, (Hq, Hkv)
        return {
            "x": _w((lambda *s: torch.randn(*s, dtype=torch.bfloat16) * 0.8)(B, Sq, D)),
            "k_cache": _w((lambda *s: torch.randn(*s, dtype=torch.bfloat16) * 0.8)(B, Hkv, Sk, Dh)),
            "v_cache": _w((lambda *s: torch.randn(*s, dtype=torch.bfloat16) * 0.05)(B, Hkv, Sk, Dh)),
            "wq": _w((lambda *s: torch.randn(*s, dtype=torch.bfloat16) * 0.8)(D, Hq * Dh) * (D ** -0.5)),
            "wo": _w((lambda *s: torch.randn(*s, dtype=torch.bfloat16) * 0.05)(Hq * Dh, D) * ((Hq * Dh) ** -0.5)),
        }
    _B_in = _B_setup()

    return {
        "A_x": _A_in["x"],
        "A_k_cache": _A_in["k_cache"],
        "A_v_cache": _A_in["v_cache"],
        "A_wq": _A_in["wq"],
        "A_wo": _A_in["wo"],
        "B_x": _B_in["x"],
        "B_k_cache": _B_in["k_cache"],
        "B_v_cache": _B_in["v_cache"],
        "B_wq": _B_in["wq"],
        "B_wo": _B_in["wo"],
    }

def reference(A_x, A_k_cache, A_v_cache, A_wq, A_wo, B_x, B_k_cache, B_v_cache, B_wq, B_wo):
    def _A_ref(x, k_cache, v_cache, wq, wo):
        B, Sq, D = x.shape
        Hq, Dh = 32, 192
        Hkv = k_cache.shape[1]
        rep = Hq // Hkv
        q = (lambda x, *d: x.permute(*d))((x @ wq).reshape(B, Sq, Hq, Dh), 0, 2, 1, 3)
        k = (lambda x, n, axis: torch.repeat_interleave(x, n, dim=axis))(k_cache, rep, axis=1)
        v = (lambda x, n, axis: torch.repeat_interleave(x, n, dim=axis))(v_cache, rep, axis=1)
        scores = torch.einsum("bhqd,bhkd->bhqk", q, k) * (Dh ** -0.5)
        p = _softmax(scores, axis=-1)
        o = torch.einsum("bhqk,bhkd->bhqd", p, v)
        return (lambda x, *d: x.permute(*d))(o, 0, 2, 1, 3).reshape(B, Sq, Hq * Dh) @ wo

    def _B_ref(x, k_cache, v_cache, wq, wo):
        B, Sq, D = x.shape
        Hq, Dh = 32, 192
        Hkv = k_cache.shape[1]
        rep = Hq // Hkv
        q = (lambda x, *d: x.permute(*d))((x @ wq).reshape(B, Sq, Hq, Dh), 0, 2, 1, 3)
        k = (lambda x, n, axis: torch.repeat_interleave(x, n, dim=axis))(k_cache, rep, axis=1)
        v = (lambda x, n, axis: torch.repeat_interleave(x, n, dim=axis))(v_cache, rep, axis=1)
        scores = torch.einsum("bhqd,bhkd->bhqk", q, k) * (Dh ** -0.5)
        p = _softmax(scores, axis=-1)
        o = torch.einsum("bhqk,bhkd->bhqd", p, v)
        return (lambda x, *d: x.permute(*d))(o, 0, 2, 1, 3).reshape(B, Sq, Hq * Dh) @ wo

    a = _A_ref(A_x, A_k_cache, A_v_cache, A_wq, A_wo)
    b = _B_ref(B_x, B_k_cache, B_v_cache, B_wq, B_wo)
    return torch.concatenate([a, b], axis=-1)
```

```asm
; @launch grid=(256,1,1) block=(512,1,1) lds=163840
.amdgcn_target "amdgcn-amd-amdhsa--gfx950"
.text
.globl concat_heads__gqa_block_cached__gqa_block_cached__near_ridge_kernel
.p2align 8
.type concat_heads__gqa_block_cached__gqa_block_cached__near_ridge_kernel,@function
concat_heads__gqa_block_cached__gqa_block_cached__near_ridge_kernel:
TAIL_CODE:
    s_cmp_ge_u32 s2, 256
    s_cbranch_scc1 kend_1
    s_and_b32 s36, s2, 7
    s_lshr_b32 s38, s36, 2
    s_mul_i32 s52, s38, 40
    s_add_u32 s62, s0, s52
    s_addc_u32 s63, s1, 0
    s_load_dwordx4 s[64:67], s[62:63], 0
    s_load_dwordx4 s[68:71], s[62:63], 16
    s_load_dwordx2 s[72:73], s[62:63], 32
    s_load_dwordx4 s[76:79], s[0:1], 80
    s_load_dwordx2 s[74:75], s[0:1], 96
    v_lshlrev_b32 v1, 7, v0
    s_getpc_b64 s[48:49]
pc_3:
    s_add_u32 s48, s48, TAIL_CODE-pc_3
    s_addc_u32 s49, s49, -1
    s_and_b32 s49, s49, 0xffff
    s_mov_b32 s50, TAIL_END-TAIL_CODE
    s_mov_b32 s51, 0x20000
    buffer_load_dword v35, v1, s[48:51], 0 offen
    v_lshrrev_b32 v1, 6, v0
    v_and_b32 v0, 63, v0
    s_lshr_b32 s37, s2, 3
    v_readfirstlane_b32 s3, v1
    s_and_b32 s39, s36, 3
    s_and_b32 s42, s37, 7
    s_lshl_b32 s40, s39, 3
    s_add_u32 s40, s40, s42
    s_lshr_b32 s41, s37, 3
    s_and_b32 s43, s3, 3
    s_and_b32 s46, s3, 1
    s_bfe_u32 s47, s3, 0x10001
    s_cmp_lt_u32 s3, 4
    s_cbranch_scc1 kcomp_2
    v_lshrrev_b32 v44, 3, v0
    v_and_b32 v45, 7, v0
    v_lshrrev_b32 v46, 4, v0
    v_and_b32 v47, 1, v46
    s_lshl_b32 s48, s46, 5
    s_mul_i32 s49, s40, 384
    s_mov_b32 s50, 12288
    v_add_u32 v48, s48, v44
    v_mul_lo_u32 v48, v48, s50
    v_or_b32 v49, 0, v47
    v_lshlrev_b32 v49, 1, v49
    v_xor_b32 v49, v49, v45
    v_lshlrev_b32 v49, 4, v49
    v_add3_u32 v2, v48, v49, s49
    v_add_u32 v48, s48, v44
    v_add_u32 v48, 8, v48
    v_mul_lo_u32 v48, v48, s50
    v_or_b32 v49, 2, v47
    v_lshlrev_b32 v49, 1, v49
    v_xor_b32 v49, v49, v45
    v_lshlrev_b32 v49, 4, v49
    v_add3_u32 v3, v48, v49, s49
    s_mul_i32 s48, s41, 192
    s_mul_i32 s49, s46, 96
    s_add_u32 s48, s48, s49
    v_add_u32 v48, s48, v44
    v_mul_u32_u24 v48, 1280, v48
    v_or_b32 v49, 0, v46
    v_xor_b32 v49, v49, v45
    v_lshl_add_u32 v4, v49, 4, v48
    v_add_u32 v48, s48, v44
    v_add_u32 v48, 8, v48
    v_mul_u32_u24 v48, 1280, v48
    v_or_b32 v49, 4, v46
    v_xor_b32 v49, v49, v45
    v_lshl_add_u32 v5, v49, 4, v48
    s_lshl_b32 s59, s46, 12
    s_mul_i32 s60, s46, 12288
    s_add_u32 s60, s60, 24576
    s_mul_i32 s48, s41, 5
    s_lshr_b32 s48, s48, 1
    s_add_u32 s48, s41, s42
    s_and_b32 s48, s48, 1
    s_mul_i32 s98, s48, 5
    s_add_u32 s98, s98, s47
    s_cmp_ge_u32 s98, 10
    s_cselect_b32 s48, 10, 0
    s_sub_u32 s98, s98, s48
    s_mov_b32 s99, s41
    s_cmp_eq_u32 s47, 1
    s_cbranch_scc1 pairb_4
    s_cmp_eq_u32 s99, 1
    s_cbranch_scc1 ph_9
    s_cmp_eq_u32 s99, 3
    s_cbranch_scc1 ph_9
ph_8:
    s_waitcnt lgkmcnt(0)
    s_mov_b32 s8, s70
    s_and_b32 s9, s71, 0xffff
    s_mov_b32 s10, 7864320
    s_mov_b32 s11, 0x20000
    s_mov_b32 s12, s64
    s_and_b32 s13, s65, 0xffff
    s_mov_b32 s14, 983040
    s_mov_b32 s15, 0x20000
    s_mul_i32 s49, s98, 786432
    s_add_u32 s50, s49, 196608
    s_add_u32 m0, s59, 0
    s_nop 0
    buffer_load_dwordx4 v2, s[8:11], s49 offen offset:0 lds
    s_add_u32 m0, s59, 8064
    s_nop 0
    buffer_load_dwordx4 v2, s[8:11], s49 offen offset:128 lds
    s_add_u32 m0, s59, 16128
    s_nop 0
    buffer_load_dwordx4 v2, s[8:11], s49 offen offset:256 lds
    s_add_u32 m0, s59, 1024
    s_nop 0
    buffer_load_dwordx4 v3, s[8:11], s49 offen offset:0 lds
    s_add_u32 m0, s59, 9088
    s_nop 0
    buffer_load_dwordx4 v3, s[8:11], s49 offen offset:128 lds
    s_add_u32 m0, s59, 17152
    s_nop 0
    buffer_load_dwordx4 v3, s[8:11], s49 offen offset:256 lds
    s_add_u32 m0, s59, 2048
    s_nop 0
    buffer_load_dwordx4 v2, s[8:11], s50 offen offset:0 lds
    s_add_u32 m0, s59, 10112
    s_nop 0
    buffer_load_dwordx4 v2, s[8:11], s50 offen offset:128 lds
    s_add_u32 m0, s59, 18176
    s_nop 0
    buffer_load_dwordx4 v2, s[8:11], s50 offen offset:256 lds
    s_add_u32 m0, s59, 3072
    s_nop 0
    buffer_load_dwordx4 v3, s[8:11], s50 offen offset:0 lds
    s_add_u32 m0, s59, 11136
    s_nop 0
    buffer_load_dwordx4 v3, s[8:11], s50 offen offset:128 lds
    s_add_u32 m0, s59, 19200
    s_nop 0
    buffer_load_dwordx4 v3, s[8:11], s50 offen offset:256 lds
    s_lshl_b32 s49, s98, 7
    s_add_u32 m0, s60, 0
    s_add_u32 s58, s49, 0
    buffer_load_dwordx4 v4, s[12:15], s58 offen lds
    s_add_u32 m0, s60, 1024
    s_add_u32 s58, s49, 0
    buffer_load_dwordx4 v5, s[12:15], s58 offen lds
    s_add_u32 m0, s60, 2048
    s_add_u32 s58, s49, 20480
    buffer_load_dwordx4 v4, s[12:15], s58 offen lds
    s_add_u32 m0, s60, 3072
    s_add_u32 s58, s49, 20480
    buffer_load_dwordx4 v5, s[12:15], s58 offen lds
    s_add_u32 m0, s60, 4096
    s_add_u32 s58, s49, 40960
    buffer_load_dwordx4 v4, s[12:15], s58 offen lds
    s_add_u32 m0, s60, 5120
    s_add_u32 s58, s49, 40960
    buffer_load_dwordx4 v5, s[12:15], s58 offen lds
    s_add_u32 m0, s60, 6144
    s_add_u32 s58, s49, 61440
    buffer_load_dwordx4 v4, s[12:15], s58 offen lds
    s_add_u32 m0, s60, 7168
    s_add_u32 s58, s49, 61440
    buffer_load_dwordx4 v5, s[12:15], s58 offen lds
    s_add_u32 m0, s60, 8192
    s_add_u32 s58, s49, 81920
    buffer_load_dwordx4 v4, s[12:15], s58 offen lds
    s_add_u32 m0, s60, 9216
    s_add_u32 s58, s49, 81920
    buffer_load_dwordx4 v5, s[12:15], s58 offen lds
    s_add_u32 m0, s60, 10240
    s_add_u32 s58, s49, 102400
    buffer_load_dwordx4 v4, s[12:15], s58 offen lds
    s_add_u32 m0, s60, 11264
    s_add_u32 s58, s49, 102400
    buffer_load_dwordx4 v5, s[12:15], s58 offen lds
    s_add_u32 s98, s98, 2
    s_cmp_ge_u32 s98, 10
    s_cselect_b32 s49, 10, 0
    s_sub_u32 s98, s98, s49
    s_mov_b32 s24, s74
    s_and_b32 s25, s75, 0xffff
    s_mov_b32 s26, 268435456
    s_mov_b32 s27, 0x20000
    s_mov_b32 s16, s66
    s_and_b32 s17, s67, 0xffff
    s_mov_b32 s18, 9437184
    s_mov_b32 s19, 0x20000
    s_mov_b32 s20, s68
    s_and_b32 s21, s69, 0xffff
    s_mov_b32 s22, 9437184
    s_mov_b32 s23, 0x20000
    s_mov_b32 s28, s72
    s_and_b32 s29, s73, 0xffff
    s_mov_b32 s30, 7864320
    s_mov_b32 s31, 0x20000
    s_mov_b32 s32, s76
    s_and_b32 s33, s77, 0xffff
    s_mov_b32 s34, 1966080
    s_mov_b32 s35, 0x20000
    s_mov_b32 s4, s78
    s_and_b32 s5, s79, 0xffff
    s_mov_b32 s6, 256
    s_mov_b32 s7, 0x20000
    s_lshl_b32 s48, s38, 2
    s_add_u32 s48, s48, s41
    s_lshl_b32 s48, s48, 13
    s_add_u32 s54, s48, 41943040
    s_lshr_b32 s48, s42, 2
    s_lshl_b32 s55, s39, 1
    s_add_u32 s55, s55, s48
    s_lshl_b32 s48, s43, 2
    s_add_u32 s48, s48, 163328
    v_lshlrev_b32 v34, 2, v0
    v_add_u32 v34, 163584, v34
    v_cmp_eq_u32 vcc, 0, v0
    v_mov_b32 v32, s48
    v_mov_b32 v33, 163344
    v_cndmask_b32 v32, v34, v32, vcc
    v_mov_b32 v34, 0
    ds_write_b32 v32, v34
    s_waitcnt lgkmcnt(0)
    s_barrier
    s_lshl_b32 s48, s41, 2
    s_add_u32 s48, s48, s43
    s_lshl_b32 s48, s48, 5
    s_add_u32 s48, s48, s40
    s_mul_i32 s48, s48, 18432
    v_mul_u32_u24 v48, 384, v44
    v_lshl_add_u32 v48, v45, 4, v48
    v_add_u32 v6, s48, v48
    s_mul_i32 s49, s43, 18432
    s_add_u32 s49, s49, 89600
    v_lshlrev_b32 v48, 7, v44
    v_or_b32 v49, 0, v46
    v_xor_b32 v49, v49, v45
    v_lshl_add_u32 v49, v49, 4, v48
    v_add_u32 v7, s49, v49
    v_or_b32 v49, 4, v46
    v_xor_b32 v49, v49, v45
    v_lshl_add_u32 v49, v49, 4, v48
    v_add_u32 v8, s49, v49
    s_mul_i32 s48, s43, 6144
    v_lshlrev_b32 v49, 1, v46
    v_xor_b32 v49, v49, v45
    v_lshl_add_u32 v49, v49, 4, v48
    v_add_u32 v9, s48, v49
    v_mul_u32_u24 v49, 0x5556, v0
    v_lshrrev_b32 v49, 16, v49
    v_mul_u32_u24 v50, 3, v49
    v_sub_u32 v50, v0, v50
    s_mul_i32 s48, s41, 48
    s_mul_i32 s49, s43, 12
    s_add_u32 s48, s48, s49
    s_mul_i32 s49, s55, 768
    s_add_u32 s48, s48, s49
    s_mul_i32 s48, s48, 1280
    s_and_b32 s49, s42, 3
    s_mul_i32 s49, s49, 320
    s_and_b32 s49, s49, 0xffffff80
    s_add_u32 s48, s48, s49
    v_mul_u32_u24 v49, 1280, v49
    v_lshl_add_u32 v49, v50, 7, v49
    v_add_u32 v49, s48, v49
    v_cmp_gt_u32 vcc, 36, v0
    v_mov_b32 v50, 0x7ff00000
    s_nop 0
    v_cndmask_b32 v10, v50, v49, vcc
    v_lshlrev_b32 v64, 7, v0
    s_lshl_b32 s48, s43, 13
    v_add_u32 v64, s48, v64
    s_cmp_ge_u32 s42, 4
    s_mov_b32 s101, 0x4b72e1d8
    s_cmov_b32 s101, 0x87d2b1b4
    s_and_b32 s48, s42, 3
    s_lshl_b32 s48, s48, 3
    s_lshr_b32 s101, s101, s48
    s_mul_i32 s48, s46, 6144
    v_lshlrev_b32 v36, 4, v0
    v_add_u32 v36, s48, v36
    s_and_b32 s48, s42, 3
    s_mul_i32 s48, s48, 320
    s_mul_i32 s49, s46, 20480
    s_add_u32 s48, s48, s49
    s_movk_i32 s49, 3277
    v_add_u32 v48, 0, v0
    v_mul_lo_u32 v49, v48, s49
    v_lshrrev_b32 v49, 16, v49
    v_mul_u32_u24 v50, 20, v49
    v_sub_u32 v50, v48, v50
    v_bfe_u32 v51, v49, 2, 1
    v_lshlrev_b32 v51, 1, v51
    v_xor_b32 v50, v50, v51
    v_mul_u32_u24 v49, 1280, v49
    v_lshl_add_u32 v49, v50, 4, v49
    v_add_u32 v37, s48, v49
    v_add_u32 v48, 64, v0
    v_mul_lo_u32 v49, v48, s49
    v_lshrrev_b32 v49, 16, v49
    v_mul_u32_u24 v50, 20, v49
    v_sub_u32 v50, v48, v50
    v_bfe_u32 v51, v49, 2, 1
    v_lshlrev_b32 v51, 1, v51
    v_xor_b32 v50, v50, v51
    v_mul_u32_u24 v49, 1280, v49
    v_lshl_add_u32 v49, v50, 4, v49
    v_add_u32 v38, s48, v49
    v_add_u32 v48, 128, v0
    v_mul_lo_u32 v49, v48, s49
    v_lshrrev_b32 v49, 16, v49
    v_mul_u32_u24 v50, 20, v49
    v_sub_u32 v50, v48, v50
    v_bfe_u32 v51, v49, 2, 1
    v_lshlrev_b32 v51, 1, v51
    v_xor_b32 v50, v50, v51
    v_mul_u32_u24 v49, 1280, v49
    v_lshl_add_u32 v49, v50, 4, v49
    v_add_u32 v39, s48, v49
    v_add_u32 v48, 192, v0
    v_mul_lo_u32 v49, v48, s49
    v_lshrrev_b32 v49, 16, v49
    v_mul_u32_u24 v50, 20, v49
    v_sub_u32 v50, v48, v50
    v_bfe_u32 v51, v49, 2, 1
    v_lshlrev_b32 v51, 1, v51
    v_xor_b32 v50, v50, v51
    v_mul_u32_u24 v49, 1280, v49
    v_lshl_add_u32 v49, v50, 4, v49
    v_add_u32 v40, s48, v49
    v_add_u32 v48, 256, v0
    v_mul_lo_u32 v49, v48, s49
    v_lshrrev_b32 v49, 16, v49
    v_mul_u32_u24 v50, 20, v49
    v_sub_u32 v50, v48, v50
    v_bfe_u32 v51, v49, 2, 1
    v_lshlrev_b32 v51, 1, v51
    v_xor_b32 v50, v50, v51
    v_mul_u32_u24 v49, 1280, v49
    v_lshl_add_u32 v49, v50, 4, v49
    v_add_u32 v41, s48, v49
    s_lshl_b32 s48, s55, 7
    s_add_u32 s48, s48, s54
    v_and_b32 v42, 15, v0
    v_lshlrev_b32 v42, 2, v42
    v_add_u32 v42, s48, v42
    s_waitcnt vmcnt(0)
    s_barrier
    s_mul_i32 s49, s98, 786432
    s_add_u32 s50, s49, 196608
    s_add_u32 m0, s59, 49152
    s_nop 0
    buffer_load_dwordx4 v2, s[8:11], s49 offen offset:0 lds
    s_add_u32 m0, s59, 57216
    s_nop 0
    buffer_load_dwordx4 v2, s[8:11], s49 offen offset:128 lds
    s_add_u32 m0, s59, 65280
    s_nop 0
    buffer_load_dwordx4 v2, s[8:11], s49 offen offset:256 lds
    s_add_u32 m0, s59, 50176
    s_nop 0
    buffer_load_dwordx4 v3, s[8:11], s49 offen offset:0 lds
    s_add_u32 m0, s59, 58240
    s_nop 0
    buffer_load_dwordx4 v3, s[8:11], s49 offen offset:128 lds
    s_add_u32 m0, s59, 66304
    s_nop 0
    buffer_load_dwordx4 v3, s[8:11], s49 offen offset:256 lds
    s_add_u32 m0, s59, 51200
    s_nop 0
    buffer_load_dwordx4 v2, s[8:11], s50 offen offset:0 lds
    s_add_u32 m0, s59, 59264
    s_nop 0
    buffer_load_dwordx4 v2, s[8:11], s50 offen offset:128 lds
    s_add_u32 m0, s59, 67328
    s_nop 0
    buffer_load_dwordx4 v2, s[8:11], s50 offen offset:256 lds
    s_add_u32 m0, s59, 52224
    s_nop 0
    buffer_load_dwordx4 v3, s[8:11], s50 offen offset:0 lds
    s_add_u32 m0, s59, 60288
    s_nop 0
    buffer_load_dwordx4 v3, s[8:11], s50 offen offset:128 lds
    s_add_u32 m0, s59, 68352
    s_nop 0
    buffer_load_dwordx4 v3, s[8:11], s50 offen offset:256 lds
    s_lshl_b32 s49, s98, 7
    s_add_u32 m0, s60, 49152
    s_add_u32 s58, s49, 0
    buffer_load_dwordx4 v4, s[12:15], s58 offen lds
    s_add_u32 m0, s60, 50176
    s_add_u32 s58, s49, 0
    buffer_load_dwordx4 v5, s[12:15], s58 offen lds
    s_add_u32 m0, s60, 51200
    s_add_u32 s58, s49, 20480
    buffer_load_dwordx4 v4, s[12:15], s58 offen lds
    s_add_u32 m0, s60, 52224
    s_add_u32 s58, s49, 20480
    buffer_load_dwordx4 v5, s[12:15], s58 offen lds
    s_add_u32 m0, s60, 53248
    s_add_u32 s58, s49, 40960
    buffer_load_dwordx4 v4, s[12:15], s58 offen lds
    s_add_u32 m0, s60, 54272
    s_add_u32 s58, s49, 40960
    buffer_load_dwordx4 v5, s[12:15], s58 offen lds
    s_add_u32 m0, s60, 55296
    s_add_u32 s58, s49, 61440
    buffer_load_dwordx4 v4, s[12:15], s58 offen lds
    s_add_u32 m0, s60, 56320
    s_add_u32 s58, s49, 61440
    buffer_load_dwordx4 v5, s[12:15], s58 offen lds
    s_add_u32 m0, s60, 57344
    s_add_u32 s58, s49, 81920
    buffer_load_dwordx4 v4, s[12:15], s58 offen lds
    s_add_u32 m0, s60, 58368
    s_add_u32 s58, s49, 81920
    buffer_load_dwordx4 v5, s[12:15], s58 offen lds
    s_add_u32 m0, s60, 59392
    s_add_u32 s58, s49, 102400
    buffer_load_dwordx4 v4, s[12:15], s58 offen lds
    s_add_u32 m0, s60, 60416
    s_add_u32 s58, s49, 102400
    buffer_load_dwordx4 v5, s[12:15], s58 offen lds
    s_add_u32 s98, s98, 2
    s_cmp_ge_u32 s98, 10
    s_cselect_b32 s49, 10, 0
    s_sub_u32 s98, s98, s49
    s_mov_b32 s48, 0
    buffer_load_dwordx4 v[100:103], v6, s[16:19], s48 offen offset:0 nt
    s_mov_b32 s48, 0
    buffer_load_dwordx4 v[104:107], v6, s[16:19], s48 offen offset:128 nt
    s_mov_b32 s48, 0
    buffer_load_dwordx4 v[108:111], v6, s[16:19], s48 offen offset:256 nt
    s_mov_b32 s48, 0
    buffer_load_dwordx4 v[112:115], v6, s[16:19], s48 offen offset:3072 nt
    s_mov_b32 s48, 0
    buffer_load_dwordx4 v[116:119], v6, s[16:19], s48 offen offset:3200 nt
    s_mov_b32 s48, 0
    buffer_load_dwordx4 v[120:123], v6, s[16:19], s48 offen offset:3328 nt
    s_mov_b32 s48, 6144
    buffer_load_dwordx4 v[124:127], v6, s[16:19], s48 offen offset:0 nt
    s_mov_b32 s48, 6144
    buffer_load_dwordx4 v[128:131], v6, s[16:19], s48 offen offset:128 nt
    s_mov_b32 s48, 6144
    buffer_load_dwordx4 v[132:135], v6, s[16:19], s48 offen offset:256 nt
    s_barrier
    s_waitcnt vmcnt(9)
    s_barrier
    s_mul_i32 s49, s98, 786432
    s_add_u32 s50, s49, 196608
    s_add_u32 m0, s59, 98304
    s_nop 0
    buffer_load_dwordx4 v2, s[8:11], s49 offen offset:0 lds
    s_add_u32 m0, s59, 106368
    s_nop 0
    buffer_load_dwordx4 v2, s[8:11], s49 offen offset:128 lds
    s_add_u32 m0, s59, 114432
    s_nop 0
    buffer_load_dwordx4 v2, s[8:11], s49 offen offset:256 lds
    s_add_u32 m0, s59, 99328
    s_nop 0
    buffer_load_dwordx4 v3, s[8:11], s49 offen offset:0 lds
    s_add_u32 m0, s59, 107392
    s_nop 0
    buffer_load_dwordx4 v3, s[8:11], s49 offen offset:128 lds
    s_add_u32 m0, s59, 115456
    s_nop 0
    buffer_load_dwordx4 v3, s[8:11], s49 offen offset:256 lds
    s_add_u32 m0, s59, 100352
    s_nop 0
    buffer_load_dwordx4 v2, s[8:11], s50 offen offset:0 lds
    s_add_u32 m0, s59, 108416
    s_nop 0
    buffer_load_dwordx4 v2, s[8:11], s50 offen offset:128 lds
    s_add_u32 m0, s59, 116480
    s_nop 0
    buffer_load_dwordx4 v2, s[8:11], s50 offen offset:256 lds
    s_add_u32 m0, s59, 101376
    s_nop 0
    buffer_load_dwordx4 v3, s[8:11], s50 offen offset:0 lds
    s_add_u32 m0, s59, 109440
    s_nop 0
    buffer_load_dwordx4 v3, s[8:11], s50 offen offset:128 lds
    s_add_u32 m0, s59, 117504
    s_nop 0
    buffer_load_dwordx4 v3, s[8:11], s50 offen offset:256 lds
    s_lshl_b32 s49, s98, 7
    s_add_u32 m0, s60, 98304
    s_add_u32 s58, s49, 0
    buffer_load_dwordx4 v4, s[12:15], s58 offen lds
    s_add_u32 m0, s60, 99328
    s_add_u32 s58, s49, 0
    buffer_load_dwordx4 v5, s[12:15], s58 offen lds
    s_add_u32 m0, s60, 100352
    s_add_u32 s58, s49, 20480
    buffer_load_dwordx4 v4, s[12:15], s58 offen lds
    s_add_u32 m0, s60, 101376
    s_add_u32 s58, s49, 20480
    buffer_load_dwordx4 v5, s[12:15], s58 offen lds
    s_add_u32 m0, s60, 102400
    s_add_u32 s58, s49, 40960
    buffer_load_dwordx4 v4, s[12:15], s58 offen lds
    s_add_u32 m0, s60, 103424
    s_add_u32 s58, s49, 40960
    buffer_load_dwordx4 v5, s[12:15], s58 offen lds
    s_add_u32 m0, s60, 104448
    s_add_u32 s58, s49, 61440
    buffer_load_dwordx4 v4, s[12:15], s58 offen lds
    s_add_u32 m0, s60, 105472
    s_add_u32 s58, s49, 61440
    buffer_load_dwordx4 v5, s[12:15], s58 offen lds
    s_add_u32 m0, s60, 106496
    s_add_u32 s58, s49, 81920
    buffer_load_dwordx4 v4, s[12:15], s58 offen lds
    s_add_u32 m0, s60, 107520
    s_add_u32 s58, s49, 81920
    buffer_load_dwordx4 v5, s[12:15], s58 offen lds
    s_add_u32 m0, s60, 108544
    s_add_u32 s58, s49, 102400
    buffer_load_dwordx4 v4, s[12:15], s58 offen lds
    s_add_u32 m0, s60, 109568
    s_add_u32 s58, s49, 102400
    buffer_load_dwordx4 v5, s[12:15], s58 offen lds
    s_add_u32 s98, s98, 2
    s_cmp_ge_u32 s98, 10
    s_cselect_b32 s49, 10, 0
    s_sub_u32 s98, s98, s49
    s_mov_b32 s48, 6144
    buffer_load_dwordx4 v[136:139], v6, s[16:19], s48 offen offset:3072 nt
    s_mov_b32 s48, 6144
    buffer_load_dwordx4 v[140:143], v6, s[16:19], s48 offen offset:3200 nt
    s_mov_b32 s48, 6144
    buffer_load_dwordx4 v[144:147], v6, s[16:19], s48 offen offset:3328 nt
    s_mov_b32 s48, 12288
    buffer_load_dwordx4 v[148:151], v6, s[16:19], s48 offen offset:0 nt
    s_mov_b32 s48, 12288
    buffer_load_dwordx4 v[152:155], v6, s[16:19], s48 offen offset:128 nt
    s_mov_b32 s48, 12288
    buffer_load_dwordx4 v[156:159], v6, s[16:19], s48 offen offset:256 nt
    s_mov_b32 s48, 12288
    buffer_load_dwordx4 v[160:163], v6, s[16:19], s48 offen offset:3072 nt
    s_mov_b32 s48, 12288
    buffer_load_dwordx4 v[164:167], v6, s[16:19], s48 offen offset:3200 nt
    s_mov_b32 s48, 12288
    buffer_load_dwordx4 v[168:171], v6, s[16:19], s48 offen offset:3328 nt
    s_barrier
    s_waitcnt vmcnt(9)
    s_barrier
    s_mul_i32 s49, s98, 786432
    s_add_u32 s50, s49, 196608
    s_add_u32 m0, s59, 0
    s_nop 0
    buffer_load_dwordx4 v2, s[8:11], s49 offen offset:0 lds
    s_add_u32 m0, s59, 8064
    s_nop 0
    buffer_load_dwordx4 v2, s[8:11], s49 offen offset:128 lds
    s_add_u32 m0, s59, 16128
    s_nop 0
    buffer_load_dwordx4 v2, s[8:11], s49 offen offset:256 lds
    s_add_u32 m0, s59, 1024
    s_nop 0
    buffer_load_dwordx4 v3, s[8:11], s49 offen offset:0 lds
    s_add_u32 m0, s59, 9088
    s_nop 0
    buffer_load_dwordx4 v3, s[8:11], s49 offen offset:128 lds
    s_add_u32 m0, s59, 17152
    s_nop 0
    buffer_load_dwordx4 v3, s[8:11], s49 offen offset:256 lds
    s_add_u32 m0, s59, 2048
    s_nop 0
    buffer_load_dwordx4 v2, s[8:11], s50 offen offset:0 lds
    s_add_u32 m0, s59, 10112
    s_nop 0
    buffer_load_dwordx4 v2, s[8:11], s50 offen offset:128 lds
    s_add_u32 m0, s59, 18176
    s_nop 0
    buffer_load_dwordx4 v2, s[8:11], s50 offen offset:256 lds
    s_add_u32 m0, s59, 3072
    s_nop 0
    buffer_load_dwordx4 v3, s[8:11], s50 offen offset:0 lds
    s_add_u32 m0, s59, 11136
    s_nop 0
    buffer_load_dwordx4 v3, s[8:11], s50 offen offset:128 lds
    s_add_u32 m0, s59, 19200
    s_nop 0
    buffer_load_dwordx4 v3, s[8:11], s50 offen offset:256 lds
    s_lshl_b32 s49, s98, 7
    s_add_u32 m0, s60, 0
    s_add_u32 s58, s49, 0
    buffer_load_dwordx4 v4, s[12:15], s58 offen lds
    s_add_u32 m0, s60, 1024
    s_add_u32 s58, s49, 0
    buffer_load_dwordx4 v5, s[12:15], s58 offen lds
    s_add_u32 m0, s60, 2048
    s_add_u32 s58, s49, 20480
    buffer_load_dwordx4 v4, s[12:15], s58 offen lds
    s_add_u32 m0, s60, 3072
    s_add_u32 s58, s49, 20480
    buffer_load_dwordx4 v5, s[12:15], s58 offen lds
    s_add_u32 m0, s60, 4096
    s_add_u32 s58, s49, 40960
    buffer_load_dwordx4 v4, s[12:15], s58 offen lds
    s_add_u32 m0, s60, 5120
    s_add_u32 s58, s49, 40960
    buffer_load_dwordx4 v5, s[12:15], s58 offen lds
    s_add_u32 m0, s60, 6144
    s_add_u32 s58, s49, 61440
    buffer_load_dwordx4 v4, s[12:15], s58 offen lds
    s_add_u32 m0, s60, 7168
    s_add_u32 s58, s49, 61440
    buffer_load_dwordx4 v5, s[12:15], s58 offen lds
    s_add_u32 m0, s60, 8192
    s_add_u32 s58, s49, 81920
    buffer_load_dwordx4 v4, s[12:15], s58 offen lds
    s_add_u32 m0, s60, 9216
    s_add_u32 s58, s49, 81920
    buffer_load_dwordx4 v5, s[12:15], s58 offen lds
    s_add_u32 m0, s60, 10240
    s_add_u32 s58, s49, 102400
    buffer_load_dwordx4 v4, s[12:15], s58 offen lds
    s_add_u32 m0, s60, 11264
    s_add_u32 s58, s49, 102400
    buffer_load_dwordx4 v5, s[12:15], s58 offen lds
    s_add_u32 s98, s98, 2
    s_cmp_ge_u32 s98, 10
    s_cselect_b32 s49, 10, 0
    s_sub_u32 s98, s98, s49
    s_mov_b32 s48, 0
    buffer_load_dwordx4 v[172:175], v6, s[20:23], s48 offen offset:0 nt
    s_mov_b32 s48, 0
    buffer_load_dwordx4 v[176:179], v6, s[20:23], s48 offen offset:128 nt
    s_mov_b32 s48, 0
    buffer_load_dwordx4 v[180:183], v6, s[20:23], s48 offen offset:256 nt
    s_mov_b32 s48, 0
    buffer_load_dwordx4 v[184:187], v6, s[20:23], s48 offen offset:3072 nt
    s_mov_b32 s48, 0
    buffer_load_dwordx4 v[188:191], v6, s[20:23], s48 offen offset:3200 nt
    s_mov_b32 s48, 0
    buffer_load_dwordx4 v[192:195], v6, s[20:23], s48 offen offset:3328 nt
    s_barrier
    s_waitcnt vmcnt(6)
    s_barrier
    s_mul_i32 s49, s98, 786432
    s_add_u32 s50, s49, 196608
    s_add_u32 m0, s59, 49152
    s_nop 0
    buffer_load_dwordx4 v2, s[8:11], s49 offen offset:0 lds
    s_add_u32 m0, s59, 57216
    s_nop 0
    buffer_load_dwordx4 v2, s[8:11], s49 offen offset:128 lds
    s_add_u32 m0, s59, 65280
    s_nop 0
    buffer_load_dwordx4 v2, s[8:11], s49 offen offset:256 lds
    s_add_u32 m0, s59, 50176
    s_nop 0
    buffer_load_dwordx4 v3, s[8:11], s49 offen offset:0 lds
    s_add_u32 m0, s59, 58240
    s_nop 0
    buffer_load_dwordx4 v3, s[8:11], s49 offen offset:128 lds
    s_add_u32 m0, s59, 66304
    s_nop 0
    buffer_load_dwordx4 v3, s[8:11], s49 offen offset:256 lds
    s_add_u32 m0, s59, 51200
    s_nop 0
    buffer_load_dwordx4 v2, s[8:11], s50 offen offset:0 lds
    s_add_u32 m0, s59, 59264
    s_nop 0
    buffer_load_dwordx4 v2, s[8:11], s50 offen offset:128 lds
    s_add_u32 m0, s59, 67328
    s_nop 0
    buffer_load_dwordx4 v2, s[8:11], s50 offen offset:256 lds
    s_add_u32 m0, s59, 52224
    s_nop 0
    buffer_load_dwordx4 v3, s[8:11], s50 offen offset:0 lds
    s_add_u32 m0, s59, 60288
    s_nop 0
    buffer_load_dwordx4 v3, s[8:11], s50 offen offset:128 lds
    s_add_u32 m0, s59, 68352
    s_nop 0
    buffer_load_dwordx4 v3, s[8:11], s50 offen offset:256 lds
    s_lshl_b32 s49, s98, 7
    s_add_u32 m0, s60, 49152
    s_add_u32 s58, s49, 0
    buffer_load_dwordx4 v4, s[12:15], s58 offen lds
    s_add_u32 m0, s60, 50176
    s_add_u32 s58, s49, 0
    buffer_load_dwordx4 v5, s[12:15], s58 offen lds
    s_add_u32 m0, s60, 51200
    s_add_u32 s58, s49, 20480
    buffer_load_dwordx4 v4, s[12:15], s58 offen lds
    s_add_u32 m0, s60, 52224
    s_add_u32 s58, s49, 20480
    buffer_load_dwordx4 v5, s[12:15], s58 offen lds
    s_add_u32 m0, s60, 53248
    s_add_u32 s58, s49, 40960
    buffer_load_dwordx4 v4, s[12:15], s58 offen lds
    s_add_u32 m0, s60, 54272
    s_add_u32 s58, s49, 40960
    buffer_load_dwordx4 v5, s[12:15], s58 offen lds
    s_add_u32 m0, s60, 55296
    s_add_u32 s58, s49, 61440
    buffer_load_dwordx4 v4, s[12:15], s58 offen lds
    s_add_u32 m0, s60, 56320
    s_add_u32 s58, s49, 61440
    buffer_load_dwordx4 v5, s[12:15], s58 offen lds
    s_add_u32 m0, s60, 57344
    s_add_u32 s58, s49, 81920
    buffer_load_dwordx4 v4, s[12:15], s58 offen lds
    s_add_u32 m0, s60, 58368
    s_add_u32 s58, s49, 81920
    buffer_load_dwordx4 v5, s[12:15], s58 offen lds
    s_add_u32 m0, s60, 59392
    s_add_u32 s58, s49, 102400
    buffer_load_dwordx4 v4, s[12:15], s58 offen lds
    s_add_u32 m0, s60, 60416
    s_add_u32 s58, s49, 102400
    buffer_load_dwordx4 v5, s[12:15], s58 offen lds
    s_add_u32 s98, s98, 2
    s_cmp_ge_u32 s98, 10
    s_cselect_b32 s49, 10, 0
    s_sub_u32 s98, s98, s49
    s_mov_b32 s48, 6144
    buffer_load_dwordx4 v[196:199], v6, s[20:23], s48 offen offset:0 nt
    s_mov_b32 s48, 6144
    buffer_load_dwordx4 v[200:203], v6, s[20:23], s48 offen offset:128 nt
    s_mov_b32 s48, 6144
    buffer_load_dwordx4 v[204:207], v6, s[20:23], s48 offen offset:256 nt
    s_mov_b32 s48, 6144
    buffer_load_dwordx4 v[208:211], v6, s[20:23], s48 offen offset:3072 nt
    s_mov_b32 s48, 6144
    buffer_load_dwordx4 v[212:215], v6, s[20:23], s48 offen offset:3200 nt
    s_mov_b32 s48, 6144
    buffer_load_dwordx4 v[216:219], v6, s[20:23], s48 offen offset:3328 nt
    s_barrier
    s_waitcnt vmcnt(6)
    s_barrier
    s_mov_b32 s48, 12288
    buffer_load_dwordx4 v[220:223], v6, s[20:23], s48 offen offset:0 nt
    s_mov_b32 s48, 12288
    buffer_load_dwordx4 v[224:227], v6, s[20:23], s48 offen offset:128 nt
    s_mov_b32 s48, 12288
    buffer_load_dwordx4 v[228:231], v6, s[20:23], s48 offen offset:256 nt
    s_mov_b32 s48, 12288
    buffer_load_dwordx4 v[232:235], v6, s[20:23], s48 offen offset:3072 nt
    s_mov_b32 s48, 12288
    buffer_load_dwordx4 v[236:239], v6, s[20:23], s48 offen offset:3200 nt
    s_mov_b32 s48, 12288
    buffer_load_dwordx4 v[240:243], v6, s[20:23], s48 offen offset:3328 nt
    s_barrier
    s_getpc_b64 s[48:49]
pc_10:
    s_add_u32 s48, s48, TAIL_BEGIN-pc_10
    s_addc_u32 s49, s49, 0
    s_and_b32 s49, s49, 0xffff
    s_mov_b32 s50, TAIL_END-TAIL_BEGIN
    s_mov_b32 s51, 0x20000
    buffer_load_dword v65, v64, s[48:51], 0 offen
    ds_write_b128 v7, v[100:103] offset:0
    ds_write_b128 v8, v[112:115] offset:1024
    ds_write_b128 v7, v[124:127] offset:2048
    ds_write_b128 v8, v[136:139] offset:3072
    ds_write_b128 v7, v[148:151] offset:4096
    ds_write_b128 v8, v[160:163] offset:5120
    ds_write_b128 v7, v[104:107] offset:6144
    ds_write_b128 v8, v[116:119] offset:7168
    ds_write_b128 v7, v[128:131] offset:8192
    ds_write_b128 v8, v[140:143] offset:9216
    ds_write_b128 v7, v[152:155] offset:10240
    ds_write_b128 v8, v[164:167] offset:11264
    ds_write_b128 v7, v[108:111] offset:12288
    ds_write_b128 v8, v[120:123] offset:13312
    ds_write_b128 v7, v[132:135] offset:14336
    ds_write_b128 v8, v[144:147] offset:15360
    ds_write_b128 v7, v[156:159] offset:16384
    ds_write_b128 v8, v[168:171] offset:17408
    s_waitcnt lgkmcnt(0)
    s_barrier
    s_branch p2a_6
ph_9:
    s_waitcnt lgkmcnt(0)
    s_mov_b32 s8, s70
    s_and_b32 s9, s71, 0xffff
    s_mov_b32 s10, 7864320
    s_mov_b32 s11, 0x20000
    s_mov_b32 s12, s64
    s_and_b32 s13, s65, 0xffff
    s_mov_b32 s14, 983040
    s_mov_b32 s15, 0x20000
    s_mul_i32 s49, s98, 786432
    s_add_u32 s50, s49, 196608
    s_add_u32 m0, s59, 0
    s_nop 0
    buffer_load_dwordx4 v2, s[8:11], s49 offen offset:0 lds
    s_add_u32 m0, s59, 8064
    s_nop 0
    buffer_load_dwordx4 v2, s[8:11], s49 offen offset:128 lds
    s_add_u32 m0, s59, 16128
    s_nop 0
    buffer_load_dwordx4 v2, s[8:11], s49 offen offset:256 lds
    s_add_u32 m0, s59, 1024
    s_nop 0
    buffer_load_dwordx4 v3, s[8:11], s49 offen offset:0 lds
    s_add_u32 m0, s59, 9088
    s_nop 0
    buffer_load_dwordx4 v3, s[8:11], s49 offen offset:128 lds
    s_add_u32 m0, s59, 17152
    s_nop 0
    buffer_load_dwordx4 v3, s[8:11], s49 offen offset:256 lds
    s_add_u32 m0, s59, 2048
    s_nop 0
    buffer_load_dwordx4 v2, s[8:11], s50 offen offset:0 lds
    s_add_u32 m0, s59, 10112
    s_nop 0
    buffer_load_dwordx4 v2, s[8:11], s50 offen offset:128 lds
    s_add_u32 m0, s59, 18176
    s_nop 0
    buffer_load_dwordx4 v2, s[8:11], s50 offen offset:256 lds
    s_add_u32 m0, s59, 3072
    s_nop 0
    buffer_load_dwordx4 v3, s[8:11], s50 offen offset:0 lds
    s_add_u32 m0, s59, 11136
    s_nop 0
    buffer_load_dwordx4 v3, s[8:11], s50 offen offset:128 lds
    s_add_u32 m0, s59, 19200
    s_nop 0
    buffer_load_dwordx4 v3, s[8:11], s50 offen offset:256 lds
    s_lshl_b32 s49, s98, 7
    s_add_u32 m0, s60, 0
    s_add_u32 s58, s49, 0
    buffer_load_dwordx4 v4, s[12:15], s58 offen lds
    s_add_u32 m0, s60, 1024
    s_add_u32 s58, s49, 0
    buffer_load_dwordx4 v5, s[12:15], s58 offen lds
    s_add_u32 m0, s60, 2048
    s_add_u32 s58, s49, 20480
    buffer_load_dwordx4 v4, s[12:15], s58 offen lds
    s_add_u32 m0, s60, 3072
    s_add_u32 s58, s49, 20480
    buffer_load_dwordx4 v5, s[12:15], s58 offen lds
    s_add_u32 m0, s60, 4096
    s_add_u32 s58, s49, 40960
    buffer_load_dwordx4 v4, s[12:15], s58 offen lds
    s_add_u32 m0, s60, 5120
    s_add_u32 s58, s49, 40960
    buffer_load_dwordx4 v5, s[12:15], s58 offen lds
    s_add_u32 m0, s60, 6144
    s_add_u32 s58, s49, 61440
    buffer_load_dwordx4 v4, s[12:15], s58 offen lds
    s_add_u32 m0, s60, 7168
    s_add_u32 s58, s49, 61440
    buffer_load_dwordx4 v5, s[12:15], s58 offen lds
    s_add_u32 m0, s60, 8192
    s_add_u32 s58, s49, 81920
    buffer_load_dwordx4 v4, s[12:15], s58 offen lds
    s_add_u32 m0, s60, 9216
    s_add_u32 s58, s49, 81920
    buffer_load_dwordx4 v5, s[12:15], s58 offen lds
    s_add_u32 m0, s60, 10240
    s_add_u32 s58, s49, 102400
    buffer_load_dwordx4 v4, s[12:15], s58 offen lds
    s_add_u32 m0, s60, 11264
    s_add_u32 s58, s49, 102400
    buffer_load_dwordx4 v5, s[12:15], s58 offen lds
    s_add_u32 s98, s98, 2
    s_cmp_ge_u32 s98, 10
    s_cselect_b32 s49, 10, 0
    s_sub_u32 s98, s98, s49
    s_mov_b32 s24, s74
    s_and_b32 s25, s75, 0xffff
    s_mov_b32 s26, 268435456
    s_mov_b32 s27, 0x20000
    s_mov_b32 s16, s66
    s_and_b32 s17, s67, 0xffff
    s_mov_b32 s18, 9437184
    s_mov_b32 s19, 0x20000
    s_mov_b32 s20, s68
    s_and_b32 s21, s69, 0xffff
    s_mov_b32 s22, 9437184
    s_mov_b32 s23, 0x20000
    s_mov_b32 s28, s72
    s_and_b32 s29, s73, 0xffff
    s_mov_b32 s30, 7864320
    s_mov_b32 s31, 0x20000
    s_mov_b32 s32, s76
    s_and_b32 s33, s77, 0xffff
    s_mov_b32 s34, 1966080
    s_mov_b32 s35, 0x20000
    s_mov_b32 s4, s78
    s_and_b32 s5, s79, 0xffff
    s_mov_b32 s6, 256
    s_mov_b32 s7, 0x20000
    s_lshl_b32 s48, s38, 2
    s_add_u32 s48, s48, s41
    s_lshl_b32 s48, s48, 13
    s_add_u32 s54, s48, 41943040
    s_lshr_b32 s48, s42, 2
    s_lshl_b32 s55, s39, 1
    s_add_u32 s55, s55, s48
    s_lshl_b32 s48, s43, 2
    s_add_u32 s48, s48, 163328
    v_lshlrev_b32 v34, 2, v0
    v_add_u32 v34, 163584, v34
    v_cmp_eq_u32 vcc, 0, v0
    v_mov_b32 v32, s48
    v_mov_b32 v33, 163344
    v_cndmask_b32 v32, v34, v32, vcc
    v_mov_b32 v34, 0
    ds_write_b32 v32, v34
    s_waitcnt lgkmcnt(0)
    s_barrier
    s_lshl_b32 s48, s41, 2
    s_add_u32 s48, s48, s43
    s_lshl_b32 s48, s48, 5
    s_add_u32 s48, s48, s40
    s_mul_i32 s48, s48, 18432
    v_mul_u32_u24 v48, 384, v44
    v_lshl_add_u32 v48, v45, 4, v48
    v_add_u32 v6, s48, v48
    s_mul_i32 s49, s43, 18432
    s_add_u32 s49, s49, 89600
    v_lshlrev_b32 v48, 7, v44
    v_or_b32 v49, 0, v46
    v_xor_b32 v49, v49, v45
    v_lshl_add_u32 v49, v49, 4, v48
    v_add_u32 v7, s49, v49
    v_or_b32 v49, 4, v46
    v_xor_b32 v49, v49, v45
    v_lshl_add_u32 v49, v49, 4, v48
    v_add_u32 v8, s49, v49
    s_mul_i32 s48, s43, 6144
    v_lshlrev_b32 v49, 1, v46
    v_xor_b32 v49, v49, v45
    v_lshl_add_u32 v49, v49, 4, v48
    v_add_u32 v9, s48, v49
    v_mul_u32_u24 v49, 0x5556, v0
    v_lshrrev_b32 v49, 16, v49
    v_mul_u32_u24 v50, 3, v49
    v_sub_u32 v50, v0, v50
    s_mul_i32 s48, s41, 48
    s_mul_i32 s49, s43, 12
    s_add_u32 s48, s48, s49
    s_mul_i32 s49, s55, 768
    s_add_u32 s48, s48, s49
    s_mul_i32 s48, s48, 1280
    s_and_b32 s49, s42, 3
    s_mul_i32 s49, s49, 320
    s_and_b32 s49, s49, 0xffffff80
    s_add_u32 s48, s48, s49
    v_mul_u32_u24 v49, 1280, v49
    v_lshl_add_u32 v49, v50, 7, v49
    v_add_u32 v49, s48, v49
    v_cmp_gt_u32 vcc, 36, v0
    v_mov_b32 v50, 0x7ff00000
    s_nop 0
    v_cndmask_b32 v10, v50, v49, vcc
    v_lshlrev_b32 v64, 7, v0
    s_lshl_b32 s48, s43, 13
    v_add_u32 v64, s48, v64
    s_cmp_ge_u32 s42, 4
    s_mov_b32 s101, 0x4b72e1d8
    s_cmov_b32 s101, 0x87d2b1b4
    s_and_b32 s48, s42, 3
    s_lshl_b32 s48, s48, 3
    s_lshr_b32 s101, s101, s48
    s_mul_i32 s48, s46, 6144
    v_lshlrev_b32 v36, 4, v0
    v_add_u32 v36, s48, v36
    s_and_b32 s48, s42, 3
    s_mul_i32 s48, s48, 320
    s_mul_i32 s49, s46, 20480
    s_add_u32 s48, s48, s49
    s_movk_i32 s49, 3277
    v_add_u32 v48, 0, v0
    v_mul_lo_u32 v49, v48, s49
    v_lshrrev_b32 v49, 16, v49
    v_mul_u32_u24 v50, 20, v49
    v_sub_u32 v50, v48, v50
    v_bfe_u32 v51, v49, 2, 1
    v_lshlrev_b32 v51, 1, v51
    v_xor_b32 v50, v50, v51
    v_mul_u32_u24 v49, 1280, v49
    v_lshl_add_u32 v49, v50, 4, v49
    v_add_u32 v37, s48, v49
    v_add_u32 v48, 64, v0
    v_mul_lo_u32 v49, v48, s49
    v_lshrrev_b32 v49, 16, v49
    v_mul_u32_u24 v50, 20, v49
    v_sub_u32 v50, v48, v50
    v_bfe_u32 v51, v49, 2, 1
    v_lshlrev_b32 v51, 1, v51
    v_xor_b32 v50, v50, v51
    v_mul_u32_u24 v49, 1280, v49
    v_lshl_add_u32 v49, v50, 4, v49
    v_add_u32 v38, s48, v49
    v_add_u32 v48, 128, v0
    v_mul_lo_u32 v49, v48, s49
    v_lshrrev_b32 v49, 16, v49
    v_mul_u32_u24 v50, 20, v49
    v_sub_u32 v50, v48, v50
    v_bfe_u32 v51, v49, 2, 1
    v_lshlrev_b32 v51, 1, v51
    v_xor_b32 v50, v50, v51
    v_mul_u32_u24 v49, 1280, v49
    v_lshl_add_u32 v49, v50, 4, v49
    v_add_u32 v39, s48, v49
    v_add_u32 v48, 192, v0
    v_mul_lo_u32 v49, v48, s49
    v_lshrrev_b32 v49, 16, v49
    v_mul_u32_u24 v50, 20, v49
    v_sub_u32 v50, v48, v50
    v_bfe_u32 v51, v49, 2, 1
    v_lshlrev_b32 v51, 1, v51
    v_xor_b32 v50, v50, v51
    v_mul_u32_u24 v49, 1280, v49
    v_lshl_add_u32 v49, v50, 4, v49
    v_add_u32 v40, s48, v49
    v_add_u32 v48, 256, v0
    v_mul_lo_u32 v49, v48, s49
    v_lshrrev_b32 v49, 16, v49
    v_mul_u32_u24 v50, 20, v49
    v_sub_u32 v50, v48, v50
    v_bfe_u32 v51, v49, 2, 1
    v_lshlrev_b32 v51, 1, v51
    v_xor_b32 v50, v50, v51
    v_mul_u32_u24 v49, 1280, v49
    v_lshl_add_u32 v49, v50, 4, v49
    v_add_u32 v41, s48, v49
    s_lshl_b32 s48, s55, 7
    s_add_u32 s48, s48, s54
    v_and_b32 v42, 15, v0
    v_lshlrev_b32 v42, 2, v42
    v_add_u32 v42, s48, v42
    s_waitcnt vmcnt(0)
    s_barrier
    s_mul_i32 s49, s98, 786432
    s_add_u32 s50, s49, 196608
    s_add_u32 m0, s59, 49152
    s_nop 0
    buffer_load_dwordx4 v2, s[8:11], s49 offen offset:0 lds
    s_add_u32 m0, s59, 57216
    s_nop 0
    buffer_load_dwordx4 v2, s[8:11], s49 offen offset:128 lds
    s_add_u32 m0, s59, 65280
    s_nop 0
    buffer_load_dwordx4 v2, s[8:11], s49 offen offset:256 lds
    s_add_u32 m0, s59, 50176
    s_nop 0
    buffer_load_dwordx4 v3, s[8:11], s49 offen offset:0 lds
    s_add_u32 m0, s59, 58240
    s_nop 0
    buffer_load_dwordx4 v3, s[8:11], s49 offen offset:128 lds
    s_add_u32 m0, s59, 66304
    s_nop 0
    buffer_load_dwordx4 v3, s[8:11], s49 offen offset:256 lds
    s_add_u32 m0, s59, 51200
    s_nop 0
    buffer_load_dwordx4 v2, s[8:11], s50 offen offset:0 lds
    s_add_u32 m0, s59, 59264
    s_nop 0
    buffer_load_dwordx4 v2, s[8:11], s50 offen offset:128 lds
    s_add_u32 m0, s59, 67328
    s_nop 0
    buffer_load_dwordx4 v2, s[8:11], s50 offen offset:256 lds
    s_add_u32 m0, s59, 52224
    s_nop 0
    buffer_load_dwordx4 v3, s[8:11], s50 offen offset:0 lds
    s_add_u32 m0, s59, 60288
    s_nop 0
    buffer_load_dwordx4 v3, s[8:11], s50 offen offset:128 lds
    s_add_u32 m0, s59, 68352
    s_nop 0
    buffer_load_dwordx4 v3, s[8:11], s50 offen offset:256 lds
    s_lshl_b32 s49, s98, 7
    s_add_u32 m0, s60, 49152
    s_add_u32 s58, s49, 0
    buffer_load_dwordx4 v4, s[12:15], s58 offen lds
    s_add_u32 m0, s60, 50176
    s_add_u32 s58, s49, 0
    buffer_load_dwordx4 v5, s[12:15], s58 offen lds
    s_add_u32 m0, s60, 51200
    s_add_u32 s58, s49, 20480
    buffer_load_dwordx4 v4, s[12:15], s58 offen lds
    s_add_u32 m0, s60, 52224
    s_add_u32 s58, s49, 20480
    buffer_load_dwordx4 v5, s[12:15], s58 offen lds
    s_add_u32 m0, s60, 53248
    s_add_u32 s58, s49, 40960
    buffer_load_dwordx4 v4, s[12:15], s58 offen lds
    s_add_u32 m0, s60, 54272
    s_add_u32 s58, s49, 40960
    buffer_load_dwordx4 v5, s[12:15], s58 offen lds
    s_add_u32 m0, s60, 55296
    s_add_u32 s58, s49, 61440
    buffer_load_dwordx4 v4, s[12:15], s58 offen lds
    s_add_u32 m0, s60, 56320
    s_add_u32 s58, s49, 61440
    buffer_load_dwordx4 v5, s[12:15], s58 offen lds
    s_add_u32 m0, s60, 57344
    s_add_u32 s58, s49, 81920
    buffer_load_dwordx4 v4, s[12:15], s58 offen lds
    s_add_u32 m0, s60, 58368
    s_add_u32 s58, s49, 81920
    buffer_load_dwordx4 v5, s[12:15], s58 offen lds
    s_add_u32 m0, s60, 59392
    s_add_u32 s58, s49, 102400
    buffer_load_dwordx4 v4, s[12:15], s58 offen lds
    s_add_u32 m0, s60, 60416
    s_add_u32 s58, s49, 102400
    buffer_load_dwordx4 v5, s[12:15], s58 offen lds
    s_add_u32 s98, s98, 2
    s_cmp_ge_u32 s98, 10
    s_cselect_b32 s49, 10, 0
    s_sub_u32 s98, s98, s49
    s_barrier
    s_waitcnt vmcnt(0)
    s_barrier
    s_mul_i32 s49, s98, 786432
    s_add_u32 s50, s49, 196608
    s_add_u32 m0, s59, 98304
    s_nop 0
    buffer_load_dwordx4 v2, s[8:11], s49 offen offset:0 lds
    s_add_u32 m0, s59, 106368
    s_nop 0
    buffer_load_dwordx4 v2, s[8:11], s49 offen offset:128 lds
    s_add_u32 m0, s59, 114432
    s_nop 0
    buffer_load_dwordx4 v2, s[8:11], s49 offen offset:256 lds
    s_add_u32 m0, s59, 99328
    s_nop 0
    buffer_load_dwordx4 v3, s[8:11], s49 offen offset:0 lds
    s_add_u32 m0, s59, 107392
    s_nop 0
    buffer_load_dwordx4 v3, s[8:11], s49 offen offset:128 lds
    s_add_u32 m0, s59, 115456
    s_nop 0
    buffer_load_dwordx4 v3, s[8:11], s49 offen offset:256 lds
    s_add_u32 m0, s59, 100352
    s_nop 0
    buffer_load_dwordx4 v2, s[8:11], s50 offen offset:0 lds
    s_add_u32 m0, s59, 108416
    s_nop 0
    buffer_load_dwordx4 v2, s[8:11], s50 offen offset:128 lds
    s_add_u32 m0, s59, 116480
    s_nop 0
    buffer_load_dwordx4 v2, s[8:11], s50 offen offset:256 lds
    s_add_u32 m0, s59, 101376
    s_nop 0
    buffer_load_dwordx4 v3, s[8:11], s50 offen offset:0 lds
    s_add_u32 m0, s59, 109440
    s_nop 0
    buffer_load_dwordx4 v3, s[8:11], s50 offen offset:128 lds
    s_add_u32 m0, s59, 117504
    s_nop 0
    buffer_load_dwordx4 v3, s[8:11], s50 offen offset:256 lds
    s_lshl_b32 s49, s98, 7
    s_add_u32 m0, s60, 98304
    s_add_u32 s58, s49, 0
    buffer_load_dwordx4 v4, s[12:15], s58 offen lds
    s_add_u32 m0, s60, 99328
    s_add_u32 s58, s49, 0
    buffer_load_dwordx4 v5, s[12:15], s58 offen lds
    s_add_u32 m0, s60, 100352
    s_add_u32 s58, s49, 20480
    buffer_load_dwordx4 v4, s[12:15], s58 offen lds
    s_add_u32 m0, s60, 101376
    s_add_u32 s58, s49, 20480
    buffer_load_dwordx4 v5, s[12:15], s58 offen lds
    s_add_u32 m0, s60, 102400
    s_add_u32 s58, s49, 40960
    buffer_load_dwordx4 v4, s[12:15], s58 offen lds
    s_add_u32 m0, s60, 103424
    s_add_u32 s58, s49, 40960
    buffer_load_dwordx4 v5, s[12:15], s58 offen lds
    s_add_u32 m0, s60, 104448
    s_add_u32 s58, s49, 61440
    buffer_load_dwordx4 v4, s[12:15], s58 offen lds
    s_add_u32 m0, s60, 105472
    s_add_u32 s58, s49, 61440
    buffer_load_dwordx4 v5, s[12:15], s58 offen lds
    s_add_u32 m0, s60, 106496
    s_add_u32 s58, s49, 81920
    buffer_load_dwordx4 v4, s[12:15], s58 offen lds
    s_add_u32 m0, s60, 107520
    s_add_u32 s58, s49, 81920
    buffer_load_dwordx4 v5, s[12:15], s58 offen lds
    s_add_u32 m0, s60, 108544
    s_add_u32 s58, s49, 102400
    buffer_load_dwordx4 v4, s[12:15], s58 offen lds
    s_add_u32 m0, s60, 109568
    s_add_u32 s58, s49, 102400
    buffer_load_dwordx4 v5, s[12:15], s58 offen lds
    s_add_u32 s98, s98, 2
    s_cmp_ge_u32 s98, 10
    s_cselect_b32 s49, 10, 0
    s_sub_u32 s98, s98, s49
    s_mov_b32 s48, 0
    buffer_load_dwordx4 v[100:103], v6, s[16:19], s48 offen offset:0 nt
    s_mov_b32 s48, 0
    buffer_load_dwordx4 v[104:107], v6, s[16:19], s48 offen offset:128 nt
    s_mov_b32 s48, 0
    buffer_load_dwordx4 v[108:111], v6, s[16:19], s48 offen offset:256 nt
    s_mov_b32 s48, 0
    buffer_load_dwordx4 v[112:115], v6, s[16:19], s48 offen offset:3072 nt
    s_mov_b32 s48, 0
    buffer_load_dwordx4 v[116:119], v6, s[16:19], s48 offen offset:3200 nt
    s_mov_b32 s48, 0
    buffer_load_dwordx4 v[120:123], v6, s[16:19], s48 offen offset:3328 nt
    s_mov_b32 s48, 6144
    buffer_load_dwordx4 v[124:127], v6, s[16:19], s48 offen offset:0 nt
    s_mov_b32 s48, 6144
    buffer_load_dwordx4 v[128:131], v6, s[16:19], s48 offen offset:128 nt
    s_mov_b32 s48, 6144
    buffer_load_dwordx4 v[132:135], v6, s[16:19], s48 offen offset:256 nt
    s_barrier
    s_waitcnt vmcnt(9)
    s_barrier
    s_mul_i32 s49, s98, 786432
    s_add_u32 s50, s49, 196608
    s_add_u32 m0, s59, 0
    s_nop 0
    buffer_load_dwordx4 v2, s[8:11], s49 offen offset:0 lds
    s_add_u32 m0, s59, 8064
    s_nop 0
    buffer_load_dwordx4 v2, s[8:11], s49 offen offset:128 lds
    s_add_u32 m0, s59, 16128
    s_nop 0
    buffer_load_dwordx4 v2, s[8:11], s49 offen offset:256 lds
    s_add_u32 m0, s59, 1024
    s_nop 0
    buffer_load_dwordx4 v3, s[8:11], s49 offen offset:0 lds
    s_add_u32 m0, s59, 9088
    s_nop 0
    buffer_load_dwordx4 v3, s[8:11], s49 offen offset:128 lds
    s_add_u32 m0, s59, 17152
    s_nop 0
    buffer_load_dwordx4 v3, s[8:11], s49 offen offset:256 lds
    s_add_u32 m0, s59, 2048
    s_nop 0
    buffer_load_dwordx4 v2, s[8:11], s50 offen offset:0 lds
    s_add_u32 m0, s59, 10112
    s_nop 0
    buffer_load_dwordx4 v2, s[8:11], s50 offen offset:128 lds
    s_add_u32 m0, s59, 18176
    s_nop 0
    buffer_load_dwordx4 v2, s[8:11], s50 offen offset:256 lds
    s_add_u32 m0, s59, 3072
    s_nop 0
    buffer_load_dwordx4 v3, s[8:11], s50 offen offset:0 lds
    s_add_u32 m0, s59, 11136
    s_nop 0
    buffer_load_dwordx4 v3, s[8:11], s50 offen offset:128 lds
    s_add_u32 m0, s59, 19200
    s_nop 0
    buffer_load_dwordx4 v3, s[8:11], s50 offen offset:256 lds
    s_lshl_b32 s49, s98, 7
    s_add_u32 m0, s60, 0
    s_add_u32 s58, s49, 0
    buffer_load_dwordx4 v4, s[12:15], s58 offen lds
    s_add_u32 m0, s60, 1024
    s_add_u32 s58, s49, 0
    buffer_load_dwordx4 v5, s[12:15], s58 offen lds
    s_add_u32 m0, s60, 2048
    s_add_u32 s58, s49, 20480
    buffer_load_dwordx4 v4, s[12:15], s58 offen lds
    s_add_u32 m0, s60, 3072
    s_add_u32 s58, s49, 20480
    buffer_load_dwordx4 v5, s[12:15], s58 offen lds
    s_add_u32 m0, s60, 4096
    s_add_u32 s58, s49, 40960
    buffer_load_dwordx4 v4, s[12:15], s58 offen lds
    s_add_u32 m0, s60, 5120
    s_add_u32 s58, s49, 40960
    buffer_load_dwordx4 v5, s[12:15], s58 offen lds
    s_add_u32 m0, s60, 6144
    s_add_u32 s58, s49, 61440
    buffer_load_dwordx4 v4, s[12:15], s58 offen lds
    s_add_u32 m0, s60, 7168
    s_add_u32 s58, s49, 61440
    buffer_load_dwordx4 v5, s[12:15], s58 offen lds
    s_add_u32 m0, s60, 8192
    s_add_u32 s58, s49, 81920
    buffer_load_dwordx4 v4, s[12:15], s58 offen lds
    s_add_u32 m0, s60, 9216
    s_add_u32 s58, s49, 81920
    buffer_load_dwordx4 v5, s[12:15], s58 offen lds
    s_add_u32 m0, s60, 10240
    s_add_u32 s58, s49, 102400
    buffer_load_dwordx4 v4, s[12:15], s58 offen lds
    s_add_u32 m0, s60, 11264
    s_add_u32 s58, s49, 102400
    buffer_load_dwordx4 v5, s[12:15], s58 offen lds
    s_add_u32 s98, s98, 2
    s_cmp_ge_u32 s98, 10
    s_cselect_b32 s49, 10, 0
    s_sub_u32 s98, s98, s49
    s_mov_b32 s48, 6144
    buffer_load_dwordx4 v[136:139], v6, s[16:19], s48 offen offset:3072 nt
    s_mov_b32 s48, 6144
    buffer_load_dwordx4 v[140:143], v6, s[16:19], s48 offen offset:3200 nt
    s_mov_b32 s48, 6144
    buffer_load_dwordx4 v[144:147], v6, s[16:19], s48 offen offset:3328 nt
    s_mov_b32 s48, 12288
    buffer_load_dwordx4 v[148:151], v6, s[16:19], s48 offen offset:0 nt
    s_mov_b32 s48, 12288
    buffer_load_dwordx4 v[152:155], v6, s[16:19], s48 offen offset:128 nt
    s_mov_b32 s48, 12288
    buffer_load_dwordx4 v[156:159], v6, s[16:19], s48 offen offset:256 nt
    s_mov_b32 s48, 12288
    buffer_load_dwordx4 v[160:163], v6, s[16:19], s48 offen offset:3072 nt
    s_mov_b32 s48, 12288
    buffer_load_dwordx4 v[164:167], v6, s[16:19], s48 offen offset:3200 nt
    s_mov_b32 s48, 12288
    buffer_load_dwordx4 v[168:171], v6, s[16:19], s48 offen offset:3328 nt
    s_barrier
    s_waitcnt vmcnt(9)
    s_barrier
    s_mul_i32 s49, s98, 786432
    s_add_u32 s50, s49, 196608
    s_add_u32 m0, s59, 49152
    s_nop 0
    buffer_load_dwordx4 v2, s[8:11], s49 offen offset:0 lds
    s_add_u32 m0, s59, 57216
    s_nop 0
    buffer_load_dwordx4 v2, s[8:11], s49 offen offset:128 lds
    s_add_u32 m0, s59, 65280
    s_nop 0
    buffer_load_dwordx4 v2, s[8:11], s49 offen offset:256 lds
    s_add_u32 m0, s59, 50176
    s_nop 0
    buffer_load_dwordx4 v3, s[8:11], s49 offen offset:0 lds
    s_add_u32 m0, s59, 58240
    s_nop 0
    buffer_load_dwordx4 v3, s[8:11], s49 offen offset:128 lds
    s_add_u32 m0, s59, 66304
    s_nop 0
    buffer_load_dwordx4 v3, s[8:11], s49 offen offset:256 lds
    s_add_u32 m0, s59, 51200
    s_nop 0
    buffer_load_dwordx4 v2, s[8:11], s50 offen offset:0 lds
    s_add_u32 m0, s59, 59264
    s_nop 0
    buffer_load_dwordx4 v2, s[8:11], s50 offen offset:128 lds
    s_add_u32 m0, s59, 67328
    s_nop 0
    buffer_load_dwordx4 v2, s[8:11], s50 offen offset:256 lds
    s_add_u32 m0, s59, 52224
    s_nop 0
    buffer_load_dwordx4 v3, s[8:11], s50 offen offset:0 lds
    s_add_u32 m0, s59, 60288
    s_nop 0
    buffer_load_dwordx4 v3, s[8:11], s50 offen offset:128 lds
    s_add_u32 m0, s59, 68352
    s_nop 0
    buffer_load_dwordx4 v3, s[8:11], s50 offen offset:256 lds
    s_lshl_b32 s49, s98, 7
    s_add_u32 m0, s60, 49152
    s_add_u32 s58, s49, 0
    buffer_load_dwordx4 v4, s[12:15], s58 offen lds
    s_add_u32 m0, s60, 50176
    s_add_u32 s58, s49, 0
    buffer_load_dwordx4 v5, s[12:15], s58 offen lds
    s_add_u32 m0, s60, 51200
    s_add_u32 s58, s49, 20480
    buffer_load_dwordx4 v4, s[12:15], s58 offen lds
    s_add_u32 m0, s60, 52224
    s_add_u32 s58, s49, 20480
    buffer_load_dwordx4 v5, s[12:15], s58 offen lds
    s_add_u32 m0, s60, 53248
    s_add_u32 s58, s49, 40960
    buffer_load_dwordx4 v4, s[12:15], s58 offen lds
    s_add_u32 m0, s60, 54272
    s_add_u32 s58, s49, 40960
    buffer_load_dwordx4 v5, s[12:15], s58 offen lds
    s_add_u32 m0, s60, 55296
    s_add_u32 s58, s49, 61440
    buffer_load_dwordx4 v4, s[12:15], s58 offen lds
    s_add_u32 m0, s60, 56320
    s_add_u32 s58, s49, 61440
    buffer_load_dwordx4 v5, s[12:15], s58 offen lds
    s_add_u32 m0, s60, 57344
    s_add_u32 s58, s49, 81920
    buffer_load_dwordx4 v4, s[12:15], s58 offen lds
    s_add_u32 m0, s60, 58368
    s_add_u32 s58, s49, 81920
    buffer_load_dwordx4 v5, s[12:15], s58 offen lds
    s_add_u32 m0, s60, 59392
    s_add_u32 s58, s49, 102400
    buffer_load_dwordx4 v4, s[12:15], s58 offen lds
    s_add_u32 m0, s60, 60416
    s_add_u32 s58, s49, 102400
    buffer_load_dwordx4 v5, s[12:15], s58 offen lds
    s_add_u32 s98, s98, 2
    s_cmp_ge_u32 s98, 10
    s_cselect_b32 s49, 10, 0
    s_sub_u32 s98, s98, s49
    s_mov_b32 s48, 0
    buffer_load_dwordx4 v[172:175], v6, s[20:23], s48 offen offset:0 nt
    s_mov_b32 s48, 0
    buffer_load_dwordx4 v[176:179], v6, s[20:23], s48 offen offset:128 nt
    s_mov_b32 s48, 0
    buffer_load_dwordx4 v[180:183], v6, s[20:23], s48 offen offset:256 nt
    s_mov_b32 s48, 0
    buffer_load_dwordx4 v[184:187], v6, s[20:23], s48 offen offset:3072 nt
    s_mov_b32 s48, 0
    buffer_load_dwordx4 v[188:191], v6, s[20:23], s48 offen offset:3200 nt
    s_mov_b32 s48, 0
    buffer_load_dwordx4 v[192:195], v6, s[20:23], s48 offen offset:3328 nt
    s_mov_b32 s48, 6144
    buffer_load_dwordx4 v[196:199], v6, s[20:23], s48 offen offset:0 nt
    s_mov_b32 s48, 6144
    buffer_load_dwordx4 v[200:203], v6, s[20:23], s48 offen offset:128 nt
    s_mov_b32 s48, 6144
    buffer_load_dwordx4 v[204:207], v6, s[20:23], s48 offen offset:256 nt
    s_barrier
    s_waitcnt vmcnt(9)
    s_barrier
    s_mov_b32 s48, 6144
    buffer_load_dwordx4 v[208:211], v6, s[20:23], s48 offen offset:3072 nt
    s_mov_b32 s48, 6144
    buffer_load_dwordx4 v[212:215], v6, s[20:23], s48 offen offset:3200 nt
    s_mov_b32 s48, 6144
    buffer_load_dwordx4 v[216:219], v6, s[20:23], s48 offen offset:3328 nt
    s_mov_b32 s48, 12288
    buffer_load_dwordx4 v[220:223], v6, s[20:23], s48 offen offset:0 nt
    s_mov_b32 s48, 12288
    buffer_load_dwordx4 v[224:227], v6, s[20:23], s48 offen offset:128 nt
    s_mov_b32 s48, 12288
    buffer_load_dwordx4 v[228:231], v6, s[20:23], s48 offen offset:256 nt
    s_mov_b32 s48, 12288
    buffer_load_dwordx4 v[232:235], v6, s[20:23], s48 offen offset:3072 nt
    s_mov_b32 s48, 12288
    buffer_load_dwordx4 v[236:239], v6, s[20:23], s48 offen offset:3200 nt
    s_mov_b32 s48, 12288
    buffer_load_dwordx4 v[240:243], v6, s[20:23], s48 offen offset:3328 nt
    s_barrier
    s_getpc_b64 s[48:49]
pc_11:
    s_add_u32 s48, s48, TAIL_BEGIN-pc_11
    s_addc_u32 s49, s49, 0
    s_and_b32 s49, s49, 0xffff
    s_mov_b32 s50, TAIL_END-TAIL_BEGIN
    s_mov_b32 s51, 0x20000
    buffer_load_dword v65, v64, s[48:51], 0 offen
    ds_write_b128 v7, v[100:103] offset:0
    ds_write_b128 v8, v[112:115] offset:1024
    ds_write_b128 v7, v[124:127] offset:2048
    ds_write_b128 v8, v[136:139] offset:3072
    ds_write_b128 v7, v[148:151] offset:4096
    ds_write_b128 v8, v[160:163] offset:5120
    ds_write_b128 v7, v[104:107] offset:6144
    ds_write_b128 v8, v[116:119] offset:7168
    ds_write_b128 v7, v[128:131] offset:8192
    ds_write_b128 v8, v[140:143] offset:9216
    ds_write_b128 v7, v[152:155] offset:10240
    ds_write_b128 v8, v[164:167] offset:11264
    ds_write_b128 v7, v[108:111] offset:12288
    ds_write_b128 v8, v[120:123] offset:13312
    ds_write_b128 v7, v[132:135] offset:14336
    ds_write_b128 v8, v[144:147] offset:15360
    ds_write_b128 v7, v[156:159] offset:16384
    ds_write_b128 v8, v[168:171] offset:17408
    s_waitcnt lgkmcnt(0)
    s_barrier
    s_branch p2a_6
pairb_4:
    s_cmp_eq_u32 s99, 1
    s_cbranch_scc1 ph_13
    s_cmp_eq_u32 s99, 3
    s_cbranch_scc1 ph_13
ph_12:
    s_waitcnt lgkmcnt(0)
    s_mov_b32 s8, s70
    s_and_b32 s9, s71, 0xffff
    s_mov_b32 s10, 7864320
    s_mov_b32 s11, 0x20000
    s_mov_b32 s12, s64
    s_and_b32 s13, s65, 0xffff
    s_mov_b32 s14, 983040
    s_mov_b32 s15, 0x20000
    s_mov_b32 s24, s74
    s_and_b32 s25, s75, 0xffff
    s_mov_b32 s26, 268435456
    s_mov_b32 s27, 0x20000
    s_mov_b32 s16, s66
    s_and_b32 s17, s67, 0xffff
    s_mov_b32 s18, 9437184
    s_mov_b32 s19, 0x20000
    s_mov_b32 s20, s68
    s_and_b32 s21, s69, 0xffff
    s_mov_b32 s22, 9437184
    s_mov_b32 s23, 0x20000
    s_mov_b32 s28, s72
    s_and_b32 s29, s73, 0xffff
    s_mov_b32 s30, 7864320
    s_mov_b32 s31, 0x20000
    s_mov_b32 s32, s76
    s_and_b32 s33, s77, 0xffff
    s_mov_b32 s34, 1966080
    s_mov_b32 s35, 0x20000
    s_mov_b32 s4, s78
    s_and_b32 s5, s79, 0xffff
    s_mov_b32 s6, 256
    s_mov_b32 s7, 0x20000
    s_lshl_b32 s48, s38, 2
    s_add_u32 s48, s48, s41
    s_lshl_b32 s48, s48, 13
    s_add_u32 s54, s48, 41943040
    s_lshr_b32 s48, s42, 2
    s_lshl_b32 s55, s39, 1
    s_add_u32 s55, s55, s48
    s_lshl_b32 s48, s43, 2
    s_add_u32 s48, s48, 163328
    v_lshlrev_b32 v34, 2, v0
    v_add_u32 v34, 163584, v34
    v_cmp_eq_u32 vcc, 0, v0
    v_mov_b32 v32, s48
    v_mov_b32 v33, 163344
    v_cndmask_b32 v32, v34, v32, vcc
    v_mov_b32 v34, 0
    ds_write_b32 v32, v34
    s_waitcnt lgkmcnt(0)
    s_lshl_b32 s48, s41, 2
    s_add_u32 s48, s48, s43
    s_lshl_b32 s48, s48, 5
    s_add_u32 s48, s48, s40
    s_mul_i32 s48, s48, 18432
    v_mul_u32_u24 v48, 384, v44
    v_lshl_add_u32 v48, v45, 4, v48
    v_add_u32 v6, s48, v48
    s_mul_i32 s49, s43, 18432
    s_add_u32 s49, s49, 89600
    v_lshlrev_b32 v48, 7, v44
    v_or_b32 v49, 0, v46
    v_xor_b32 v49, v49, v45
    v_lshl_add_u32 v49, v49, 4, v48
    v_add_u32 v7, s49, v49
    v_or_b32 v49, 4, v46
    v_xor_b32 v49, v49, v45
    v_lshl_add_u32 v49, v49, 4, v48
    v_add_u32 v8, s49, v49
    s_mul_i32 s48, s43, 6144
    v_lshlrev_b32 v49, 1, v46
    v_xor_b32 v49, v49, v45
    v_lshl_add_u32 v49, v49, 4, v48
    v_add_u32 v9, s48, v49
    v_mul_u32_u24 v49, 0x5556, v0
    v_lshrrev_b32 v49, 16, v49
    v_mul_u32_u24 v50, 3, v49
    v_sub_u32 v50, v0, v50
    s_mul_i32 s48, s41, 48
    s_mul_i32 s49, s43, 12
    s_add_u32 s48, s48, s49
    s_mul_i32 s49, s55, 768
    s_add_u32 s48, s48, s49
    s_mul_i32 s48, s48, 1280
    s_and_b32 s49, s42, 3
    s_mul_i32 s49, s49, 320
    s_and_b32 s49, s49, 0xffffff80
    s_add_u32 s48, s48, s49
    v_mul_u32_u24 v49, 1280, v49
    v_lshl_add_u32 v49, v50, 7, v49
    v_add_u32 v49, s48, v49
    v_cmp_gt_u32 vcc, 36, v0
    v_mov_b32 v50, 0x7ff00000
    s_nop 0
    v_cndmask_b32 v10, v50, v49, vcc
    v_lshlrev_b32 v64, 7, v0
    s_lshl_b32 s48, s43, 13
    v_add_u32 v64, s48, v64
    s_cmp_ge_u32 s42, 4
    s_mov_b32 s101, 0x4b72e1d8
    s_cmov_b32 s101, 0x87d2b1b4
    s_and_b32 s48, s42, 3
    s_lshl_b32 s48, s48, 3
    s_lshr_b32 s101, s101, s48
    s_mul_i32 s48, s46, 6144
    v_lshlrev_b32 v36, 4, v0
    v_add_u32 v36, s48, v36
    s_and_b32 s48, s42, 3
    s_mul_i32 s48, s48, 320
    s_mul_i32 s49, s46, 20480
    s_add_u32 s48, s48, s49
    s_movk_i32 s49, 3277
    v_add_u32 v48, 0, v0
    v_mul_lo_u32 v49, v48, s49
    v_lshrrev_b32 v49, 16, v49
    v_mul_u32_u24 v50, 20, v49
    v_sub_u32 v50, v48, v50
    v_bfe_u32 v51, v49, 2, 1
    v_lshlrev_b32 v51, 1, v51
    v_xor_b32 v50, v50, v51
    v_mul_u32_u24 v49, 1280, v49
    v_lshl_add_u32 v49, v50, 4, v49
    v_add_u32 v37, s48, v49
    v_add_u32 v48, 64, v0
    v_mul_lo_u32 v49, v48, s49
    v_lshrrev_b32 v49, 16, v49
    v_mul_u32_u24 v50, 20, v49
    v_sub_u32 v50, v48, v50
    v_bfe_u32 v51, v49, 2, 1
    v_lshlrev_b32 v51, 1, v51
    v_xor_b32 v50, v50, v51
    v_mul_u32_u24 v49, 1280, v49
    v_lshl_add_u32 v49, v50, 4, v49
    v_add_u32 v38, s48, v49
    v_add_u32 v48, 128, v0
    v_mul_lo_u32 v49, v48, s49
    v_lshrrev_b32 v49, 16, v49
    v_mul_u32_u24 v50, 20, v49
    v_sub_u32 v50, v48, v50
    v_bfe_u32 v51, v49, 2, 1
    v_lshlrev_b32 v51, 1, v51
    v_xor_b32 v50, v50, v51
    v_mul_u32_u24 v49, 1280, v49
    v_lshl_add_u32 v49, v50, 4, v49
    v_add_u32 v39, s48, v49
    v_add_u32 v48, 192, v0
    v_mul_lo_u32 v49, v48, s49
    v_lshrrev_b32 v49, 16, v49
    v_mul_u32_u24 v50, 20, v49
    v_sub_u32 v50, v48, v50
    v_bfe_u32 v51, v49, 2, 1
    v_lshlrev_b32 v51, 1, v51
    v_xor_b32 v50, v50, v51
    v_mul_u32_u24 v49, 1280, v49
    v_lshl_add_u32 v49, v50, 4, v49
    v_add_u32 v40, s48, v49
    v_add_u32 v48, 256, v0
    v_mul_lo_u32 v49, v48, s49
    v_lshrrev_b32 v49, 16, v49
    v_mul_u32_u24 v50, 20, v49
    v_sub_u32 v50, v48, v50
    v_bfe_u32 v51, v49, 2, 1
    v_lshlrev_b32 v51, 1, v51
    v_xor_b32 v50, v50, v51
    v_mul_u32_u24 v49, 1280, v49
    v_lshl_add_u32 v49, v50, 4, v49
    v_add_u32 v41, s48, v49
    s_lshl_b32 s48, s55, 7
    s_add_u32 s48, s48, s54
    v_and_b32 v42, 15, v0
    v_lshlrev_b32 v42, 2, v42
    v_add_u32 v42, s48, v42
    s_barrier
    s_mul_i32 s49, s98, 786432
    s_add_u32 s50, s49, 196608
    s_add_u32 m0, s59, 98304
    s_nop 0
    buffer_load_dwordx4 v2, s[8:11], s49 offen offset:0 lds
    s_add_u32 m0, s59, 106368
    s_nop 0
    buffer_load_dwordx4 v2, s[8:11], s49 offen offset:128 lds
    s_add_u32 m0, s59, 114432
    s_nop 0
    buffer_load_dwordx4 v2, s[8:11], s49 offen offset:256 lds
    s_add_u32 m0, s59, 99328
    s_nop 0
    buffer_load_dwordx4 v3, s[8:11], s49 offen offset:0 lds
    s_add_u32 m0, s59, 107392
    s_nop 0
    buffer_load_dwordx4 v3, s[8:11], s49 offen offset:128 lds
    s_add_u32 m0, s59, 115456
    s_nop 0
    buffer_load_dwordx4 v3, s[8:11], s49 offen offset:256 lds
    s_add_u32 m0, s59, 100352
    s_nop 0
    buffer_load_dwordx4 v2, s[8:11], s50 offen offset:0 lds
    s_add_u32 m0, s59, 108416
    s_nop 0
    buffer_load_dwordx4 v2, s[8:11], s50 offen offset:128 lds
    s_add_u32 m0, s59, 116480
    s_nop 0
    buffer_load_dwordx4 v2, s[8:11], s50 offen offset:256 lds
    s_add_u32 m0, s59, 101376
    s_nop 0
    buffer_load_dwordx4 v3, s[8:11], s50 offen offset:0 lds
    s_add_u32 m0, s59, 109440
    s_nop 0
    buffer_load_dwordx4 v3, s[8:11], s50 offen offset:128 lds
    s_add_u32 m0, s59, 117504
    s_nop 0
    buffer_load_dwordx4 v3, s[8:11], s50 offen offset:256 lds
    s_lshl_b32 s49, s98, 7
    s_add_u32 m0, s60, 98304
    s_add_u32 s58, s49, 0
    buffer_load_dwordx4 v4, s[12:15], s58 offen lds
    s_add_u32 m0, s60, 99328
    s_add_u32 s58, s49, 0
    buffer_load_dwordx4 v5, s[12:15], s58 offen lds
    s_add_u32 m0, s60, 100352
    s_add_u32 s58, s49, 20480
    buffer_load_dwordx4 v4, s[12:15], s58 offen lds
    s_add_u32 m0, s60, 101376
    s_add_u32 s58, s49, 20480
    buffer_load_dwordx4 v5, s[12:15], s58 offen lds
    s_add_u32 m0, s60, 102400
    s_add_u32 s58, s49, 40960
    buffer_load_dwordx4 v4, s[12:15], s58 offen lds
    s_add_u32 m0, s60, 103424
    s_add_u32 s58, s49, 40960
    buffer_load_dwordx4 v5, s[12:15], s58 offen lds
    s_add_u32 m0, s60, 104448
    s_add_u32 s58, s49, 61440
    buffer_load_dwordx4 v4, s[12:15], s58 offen lds
    s_add_u32 m0, s60, 105472
    s_add_u32 s58, s49, 61440
    buffer_load_dwordx4 v5, s[12:15], s58 offen lds
    s_add_u32 m0, s60, 106496
    s_add_u32 s58, s49, 81920
    buffer_load_dwordx4 v4, s[12:15], s58 offen lds
    s_add_u32 m0, s60, 107520
    s_add_u32 s58, s49, 81920
    buffer_load_dwordx4 v5, s[12:15], s58 offen lds
    s_add_u32 m0, s60, 108544
    s_add_u32 s58, s49, 102400
    buffer_load_dwordx4 v4, s[12:15], s58 offen lds
    s_add_u32 m0, s60, 109568
    s_add_u32 s58, s49, 102400
    buffer_load_dwordx4 v5, s[12:15], s58 offen lds
    s_add_u32 s98, s98, 2
    s_cmp_ge_u32 s98, 10
    s_cselect_b32 s49, 10, 0
    s_sub_u32 s98, s98, s49
    s_barrier
    s_waitcnt vmcnt(0)
    s_barrier
    s_mul_i32 s49, s98, 786432
    s_add_u32 s50, s49, 196608
    s_add_u32 m0, s59, 0
    s_nop 0
    buffer_load_dwordx4 v2, s[8:11], s49 offen offset:0 lds
    s_add_u32 m0, s59, 8064
    s_nop 0
    buffer_load_dwordx4 v2, s[8:11], s49 offen offset:128 lds
    s_add_u32 m0, s59, 16128
    s_nop 0
    buffer_load_dwordx4 v2, s[8:11], s49 offen offset:256 lds
    s_add_u32 m0, s59, 1024
    s_nop 0
    buffer_load_dwordx4 v3, s[8:11], s49 offen offset:0 lds
    s_add_u32 m0, s59, 9088
    s_nop 0
    buffer_load_dwordx4 v3, s[8:11], s49 offen offset:128 lds
    s_add_u32 m0, s59, 17152
    s_nop 0
    buffer_load_dwordx4 v3, s[8:11], s49 offen offset:256 lds
    s_add_u32 m0, s59, 2048
    s_nop 0
    buffer_load_dwordx4 v2, s[8:11], s50 offen offset:0 lds
    s_add_u32 m0, s59, 10112
    s_nop 0
    buffer_load_dwordx4 v2, s[8:11], s50 offen offset:128 lds
    s_add_u32 m0, s59, 18176
    s_nop 0
    buffer_load_dwordx4 v2, s[8:11], s50 offen offset:256 lds
    s_add_u32 m0, s59, 3072
    s_nop 0
    buffer_load_dwordx4 v3, s[8:11], s50 offen offset:0 lds
    s_add_u32 m0, s59, 11136
    s_nop 0
    buffer_load_dwordx4 v3, s[8:11], s50 offen offset:128 lds
    s_add_u32 m0, s59, 19200
    s_nop 0
    buffer_load_dwordx4 v3, s[8:11], s50 offen offset:256 lds
    s_lshl_b32 s49, s98, 7
    s_add_u32 m0, s60, 0
    s_add_u32 s58, s49, 0
    buffer_load_dwordx4 v4, s[12:15], s58 offen lds
    s_add_u32 m0, s60, 1024
    s_add_u32 s58, s49, 0
    buffer_load_dwordx4 v5, s[12:15], s58 offen lds
    s_add_u32 m0, s60, 2048
    s_add_u32 s58, s49, 20480
    buffer_load_dwordx4 v4, s[12:15], s58 offen lds
    s_add_u32 m0, s60, 3072
    s_add_u32 s58, s49, 20480
    buffer_load_dwordx4 v5, s[12:15], s58 offen lds
    s_add_u32 m0, s60, 4096
    s_add_u32 s58, s49, 40960
    buffer_load_dwordx4 v4, s[12:15], s58 offen lds
    s_add_u32 m0, s60, 5120
    s_add_u32 s58, s49, 40960
    buffer_load_dwordx4 v5, s[12:15], s58 offen lds
    s_add_u32 m0, s60, 6144
    s_add_u32 s58, s49, 61440
    buffer_load_dwordx4 v4, s[12:15], s58 offen lds
    s_add_u32 m0, s60, 7168
    s_add_u32 s58, s49, 61440
    buffer_load_dwordx4 v5, s[12:15], s58 offen lds
    s_add_u32 m0, s60, 8192
    s_add_u32 s58, s49, 81920
    buffer_load_dwordx4 v4, s[12:15], s58 offen lds
    s_add_u32 m0, s60, 9216
    s_add_u32 s58, s49, 81920
    buffer_load_dwordx4 v5, s[12:15], s58 offen lds
    s_add_u32 m0, s60, 10240
    s_add_u32 s58, s49, 102400
    buffer_load_dwordx4 v4, s[12:15], s58 offen lds
    s_add_u32 m0, s60, 11264
    s_add_u32 s58, s49, 102400
    buffer_load_dwordx4 v5, s[12:15], s58 offen lds
    s_add_u32 s98, s98, 2
    s_cmp_ge_u32 s98, 10
    s_cselect_b32 s49, 10, 0
    s_sub_u32 s98, s98, s49
    s_mov_b32 s48, 0
    buffer_load_dwordx4 v[100:103], v6, s[16:19], s48 offen offset:0 nt
    s_mov_b32 s48, 0
    buffer_load_dwordx4 v[104:107], v6, s[16:19], s48 offen offset:128 nt
    s_mov_b32 s48, 0
    buffer_load_dwordx4 v[108:111], v6, s[16:19], s48 offen offset:256 nt
    s_mov_b32 s48, 0
    buffer_load_dwordx4 v[112:115], v6, s[16:19], s48 offen offset:3072 nt
    s_mov_b32 s48, 0
    buffer_load_dwordx4 v[116:119], v6, s[16:19], s48 offen offset:3200 nt
    s_mov_b32 s48, 0
    buffer_load_dwordx4 v[120:123], v6, s[16:19], s48 offen offset:3328 nt
    s_mov_b32 s48, 6144
    buffer_load_dwordx4 v[124:127], v6, s[16:19], s48 offen offset:0 nt
    s_mov_b32 s48, 6144
    buffer_load_dwordx4 v[128:131], v6, s[16:19], s48 offen offset:128 nt
    s_mov_b32 s48, 6144
    buffer_load_dwordx4 v[132:135], v6, s[16:19], s48 offen offset:256 nt
    s_barrier
    s_waitcnt vmcnt(9)
    s_barrier
    s_mul_i32 s49, s98, 786432
    s_add_u32 s50, s49, 196608
    s_add_u32 m0, s59, 49152
    s_nop 0
    buffer_load_dwordx4 v2, s[8:11], s49 offen offset:0 lds
    s_add_u32 m0, s59, 57216
    s_nop 0
    buffer_load_dwordx4 v2, s[8:11], s49 offen offset:128 lds
    s_add_u32 m0, s59, 65280
    s_nop 0
    buffer_load_dwordx4 v2, s[8:11], s49 offen offset:256 lds
    s_add_u32 m0, s59, 50176
    s_nop 0
    buffer_load_dwordx4 v3, s[8:11], s49 offen offset:0 lds
    s_add_u32 m0, s59, 58240
    s_nop 0
    buffer_load_dwordx4 v3, s[8:11], s49 offen offset:128 lds
    s_add_u32 m0, s59, 66304
    s_nop 0
    buffer_load_dwordx4 v3, s[8:11], s49 offen offset:256 lds
    s_add_u32 m0, s59, 51200
    s_nop 0
    buffer_load_dwordx4 v2, s[8:11], s50 offen offset:0 lds
    s_add_u32 m0, s59, 59264
    s_nop 0
    buffer_load_dwordx4 v2, s[8:11], s50 offen offset:128 lds
    s_add_u32 m0, s59, 67328
    s_nop 0
    buffer_load_dwordx4 v2, s[8:11], s50 offen offset:256 lds
    s_add_u32 m0, s59, 52224
    s_nop 0
    buffer_load_dwordx4 v3, s[8:11], s50 offen offset:0 lds
    s_add_u32 m0, s59, 60288
    s_nop 0
    buffer_load_dwordx4 v3, s[8:11], s50 offen offset:128 lds
    s_add_u32 m0, s59, 68352
    s_nop 0
    buffer_load_dwordx4 v3, s[8:11], s50 offen offset:256 lds
    s_lshl_b32 s49, s98, 7
    s_add_u32 m0, s60, 49152
    s_add_u32 s58, s49, 0
    buffer_load_dwordx4 v4, s[12:15], s58 offen lds
    s_add_u32 m0, s60, 50176
    s_add_u32 s58, s49, 0
    buffer_load_dwordx4 v5, s[12:15], s58 offen lds
    s_add_u32 m0, s60, 51200
    s_add_u32 s58, s49, 20480
    buffer_load_dwordx4 v4, s[12:15], s58 offen lds
    s_add_u32 m0, s60, 52224
    s_add_u32 s58, s49, 20480
    buffer_load_dwordx4 v5, s[12:15], s58 offen lds
    s_add_u32 m0, s60, 53248
    s_add_u32 s58, s49, 40960
    buffer_load_dwordx4 v4, s[12:15], s58 offen lds
    s_add_u32 m0, s60, 54272
    s_add_u32 s58, s49, 40960
    buffer_load_dwordx4 v5, s[12:15], s58 offen lds
    s_add_u32 m0, s60, 55296
    s_add_u32 s58, s49, 61440
    buffer_load_dwordx4 v4, s[12:15], s58 offen lds
    s_add_u32 m0, s60, 56320
    s_add_u32 s58, s49, 61440
    buffer_load_dwordx4 v5, s[12:15], s58 offen lds
    s_add_u32 m0, s60, 57344
    s_add_u32 s58, s49, 81920
    buffer_load_dwordx4 v4, s[12:15], s58 offen lds
    s_add_u32 m0, s60, 58368
    s_add_u32 s58, s49, 81920
    buffer_load_dwordx4 v5, s[12:15], s58 offen lds
    s_add_u32 m0, s60, 59392
    s_add_u32 s58, s49, 102400
    buffer_load_dwordx4 v4, s[12:15], s58 offen lds
    s_add_u32 m0, s60, 60416
    s_add_u32 s58, s49, 102400
    buffer_load_dwordx4 v5, s[12:15], s58 offen lds
    s_add_u32 s98, s98, 2
    s_cmp_ge_u32 s98, 10
    s_cselect_b32 s49, 10, 0
    s_sub_u32 s98, s98, s49
    s_lshl_b32 s61, s38, 2
    s_add_u32 s61, s61, s41
    s_lshl_b32 s61, s61, 2
    v_mov_b32 v53, 0
    buffer_load_dword v52, v53, s[4:7], s61 offen sc1
    s_mov_b32 s48, 6144
    buffer_load_dwordx4 v[136:139], v6, s[16:19], s48 offen offset:3072 nt
    s_mov_b32 s48, 6144
    buffer_load_dwordx4 v[140:143], v6, s[16:19], s48 offen offset:3200 nt
    s_mov_b32 s48, 6144
    buffer_load_dwordx4 v[144:147], v6, s[16:19], s48 offen offset:3328 nt
    s_mov_b32 s48, 12288
    buffer_load_dwordx4 v[148:151], v6, s[16:19], s48 offen offset:0 nt
    s_mov_b32 s48, 12288
    buffer_load_dwordx4 v[152:155], v6, s[16:19], s48 offen offset:128 nt
    s_mov_b32 s48, 12288
    buffer_load_dwordx4 v[156:159], v6, s[16:19], s48 offen offset:256 nt
    s_mov_b32 s48, 12288
    buffer_load_dwordx4 v[160:163], v6, s[16:19], s48 offen offset:3072 nt
    s_mov_b32 s48, 12288
    buffer_load_dwordx4 v[164:167], v6, s[16:19], s48 offen offset:3200 nt
    s_mov_b32 s48, 12288
    buffer_load_dwordx4 v[168:171], v6, s[16:19], s48 offen offset:3328 nt
    s_barrier
    s_waitcnt vmcnt(9)
    s_cmp_lg_u32 s43, 2
    s_cbranch_scc1 lw2_14
    s_mov_b32 s96, 0
hspoll_15:
    v_readfirstlane_b32 s62, v52
    s_add_u32 s96, s96, 1
    s_cmp_lg_u32 s62, 0
    s_cbranch_scc1 hsok_16
    s_cmp_gt_u32 s96, 1000000
    s_cbranch_scc1 hsok_16
    buffer_load_dword v52, v53, s[4:7], s61 offen sc1
    s_waitcnt vmcnt(0)
    s_branch hspoll_15
hsok_16:
lw2_14:
    s_barrier
    s_mul_i32 s49, s98, 786432
    s_add_u32 s50, s49, 196608
    s_add_u32 m0, s59, 98304
    s_nop 0
    buffer_load_dwordx4 v2, s[8:11], s49 offen offset:0 lds
    s_add_u32 m0, s59, 106368
    s_nop 0
    buffer_load_dwordx4 v2, s[8:11], s49 offen offset:128 lds
    s_add_u32 m0, s59, 114432
    s_nop 0
    buffer_load_dwordx4 v2, s[8:11], s49 offen offset:256 lds
    s_add_u32 m0, s59, 99328
    s_nop 0
    buffer_load_dwordx4 v3, s[8:11], s49 offen offset:0 lds
    s_add_u32 m0, s59, 107392
    s_nop 0
    buffer_load_dwordx4 v3, s[8:11], s49 offen offset:128 lds
    s_add_u32 m0, s59, 115456
    s_nop 0
    buffer_load_dwordx4 v3, s[8:11], s49 offen offset:256 lds
    s_add_u32 m0, s59, 100352
    s_nop 0
    buffer_load_dwordx4 v2, s[8:11], s50 offen offset:0 lds
    s_add_u32 m0, s59, 108416
    s_nop 0
    buffer_load_dwordx4 v2, s[8:11], s50 offen offset:128 lds
    s_add_u32 m0, s59, 116480
    s_nop 0
    buffer_load_dwordx4 v2, s[8:11], s50 offen offset:256 lds
    s_add_u32 m0, s59, 101376
    s_nop 0
    buffer_load_dwordx4 v3, s[8:11], s50 offen offset:0 lds
    s_add_u32 m0, s59, 109440
    s_nop 0
    buffer_load_dwordx4 v3, s[8:11], s50 offen offset:128 lds
    s_add_u32 m0, s59, 117504
    s_nop 0
    buffer_load_dwordx4 v3, s[8:11], s50 offen offset:256 lds
    s_lshl_b32 s49, s98, 7
    s_add_u32 m0, s60, 98304
    s_add_u32 s58, s49, 0
    buffer_load_dwordx4 v4, s[12:15], s58 offen lds
    s_add_u32 m0, s60, 99328
    s_add_u32 s58, s49, 0
    buffer_load_dwordx4 v5, s[12:15], s58 offen lds
    s_add_u32 m0, s60, 100352
    s_add_u32 s58, s49, 20480
    buffer_load_dwordx4 v4, s[12:15], s58 offen lds
    s_add_u32 m0, s60, 101376
    s_add_u32 s58, s49, 20480
    buffer_load_dwordx4 v5, s[12:15], s58 offen lds
    s_add_u32 m0, s60, 102400
    s_add_u32 s58, s49, 40960
    buffer_load_dwordx4 v4, s[12:15], s58 offen lds
    s_add_u32 m0, s60, 103424
    s_add_u32 s58, s49, 40960
    buffer_load_dwordx4 v5, s[12:15], s58 offen lds
    s_add_u32 m0, s60, 104448
    s_add_u32 s58, s49, 61440
    buffer_load_dwordx4 v4, s[12:15], s58 offen lds
    s_add_u32 m0, s60, 105472
    s_add_u32 s58, s49, 61440
    buffer_load_dwordx4 v5, s[12:15], s58 offen lds
    s_add_u32 m0, s60, 106496
    s_add_u32 s58, s49, 81920
    buffer_load_dwordx4 v4, s[12:15], s58 offen lds
    s_add_u32 m0, s60, 107520
    s_add_u32 s58, s49, 81920
    buffer_load_dwordx4 v5, s[12:15], s58 offen lds
    s_add_u32 m0, s60, 108544
    s_add_u32 s58, s49, 102400
    buffer_load_dwordx4 v4, s[12:15], s58 offen lds
    s_add_u32 m0, s60, 109568
    s_add_u32 s58, s49, 102400
    buffer_load_dwordx4 v5, s[12:15], s58 offen lds
    s_add_u32 s98, s98, 2
    s_cmp_ge_u32 s98, 10
    s_cselect_b32 s49, 10, 0
    s_sub_u32 s98, s98, s49
    s_mov_b32 s48, 0
    buffer_load_dwordx4 v[172:175], v6, s[20:23], s48 offen offset:0 nt
    s_mov_b32 s48, 0
    buffer_load_dwordx4 v[176:179], v6, s[20:23], s48 offen offset:128 nt
    s_mov_b32 s48, 0
    buffer_load_dwordx4 v[180:183], v6, s[20:23], s48 offen offset:256 nt
    s_mov_b32 s48, 0
    buffer_load_dwordx4 v[184:187], v6, s[20:23], s48 offen offset:3072 nt
    s_mov_b32 s48, 0
    buffer_load_dwordx4 v[188:191], v6, s[20:23], s48 offen offset:3200 nt
    s_mov_b32 s48, 0
    buffer_load_dwordx4 v[192:195], v6, s[20:23], s48 offen offset:3328 nt
    s_barrier
    s_waitcnt vmcnt(6)
    s_barrier
    s_mul_i32 s49, s98, 786432
    s_add_u32 s50, s49, 196608
    s_add_u32 m0, s59, 0
    s_nop 0
    buffer_load_dwordx4 v2, s[8:11], s49 offen offset:0 lds
    s_add_u32 m0, s59, 8064
    s_nop 0
    buffer_load_dwordx4 v2, s[8:11], s49 offen offset:128 lds
    s_add_u32 m0, s59, 16128
    s_nop 0
    buffer_load_dwordx4 v2, s[8:11], s49 offen offset:256 lds
    s_add_u32 m0, s59, 1024
    s_nop 0
    buffer_load_dwordx4 v3, s[8:11], s49 offen offset:0 lds
    s_add_u32 m0, s59, 9088
    s_nop 0
    buffer_load_dwordx4 v3, s[8:11], s49 offen offset:128 lds
    s_add_u32 m0, s59, 17152
    s_nop 0
    buffer_load_dwordx4 v3, s[8:11], s49 offen offset:256 lds
    s_add_u32 m0, s59, 2048
    s_nop 0
    buffer_load_dwordx4 v2, s[8:11], s50 offen offset:0 lds
    s_add_u32 m0, s59, 10112
    s_nop 0
    buffer_load_dwordx4 v2, s[8:11], s50 offen offset:128 lds
    s_add_u32 m0, s59, 18176
    s_nop 0
    buffer_load_dwordx4 v2, s[8:11], s50 offen offset:256 lds
    s_add_u32 m0, s59, 3072
    s_nop 0
    buffer_load_dwordx4 v3, s[8:11], s50 offen offset:0 lds
    s_add_u32 m0, s59, 11136
    s_nop 0
    buffer_load_dwordx4 v3, s[8:11], s50 offen offset:128 lds
    s_add_u32 m0, s59, 19200
    s_nop 0
    buffer_load_dwordx4 v3, s[8:11], s50 offen offset:256 lds
    s_lshl_b32 s49, s98, 7
    s_add_u32 m0, s60, 0
    s_add_u32 s58, s49, 0
    buffer_load_dwordx4 v4, s[12:15], s58 offen lds
    s_add_u32 m0, s60, 1024
    s_add_u32 s58, s49, 0
    buffer_load_dwordx4 v5, s[12:15], s58 offen lds
    s_add_u32 m0, s60, 2048
    s_add_u32 s58, s49, 20480
    buffer_load_dwordx4 v4, s[12:15], s58 offen lds
    s_add_u32 m0, s60, 3072
    s_add_u32 s58, s49, 20480
    buffer_load_dwordx4 v5, s[12:15], s58 offen lds
    s_add_u32 m0, s60, 4096
    s_add_u32 s58, s49, 40960
    buffer_load_dwordx4 v4, s[12:15], s58 offen lds
    s_add_u32 m0, s60, 5120
    s_add_u32 s58, s49, 40960
    buffer_load_dwordx4 v5, s[12:15], s58 offen lds
    s_add_u32 m0, s60, 6144
    s_add_u32 s58, s49, 61440
    buffer_load_dwordx4 v4, s[12:15], s58 offen lds
    s_add_u32 m0, s60, 7168
    s_add_u32 s58, s49, 61440
    buffer_load_dwordx4 v5, s[12:15], s58 offen lds
    s_add_u32 m0, s60, 8192
    s_add_u32 s58, s49, 81920
    buffer_load_dwordx4 v4, s[12:15], s58 offen lds
    s_add_u32 m0, s60, 9216
    s_add_u32 s58, s49, 81920
    buffer_load_dwordx4 v5, s[12:15], s58 offen lds
    s_add_u32 m0, s60, 10240
    s_add_u32 s58, s49, 102400
    buffer_load_dwordx4 v4, s[12:15], s58 offen lds
    s_add_u32 m0, s60, 11264
    s_add_u32 s58, s49, 102400
    buffer_load_dwordx4 v5, s[12:15], s58 offen lds
    s_add_u32 s98, s98, 2
    s_cmp_ge_u32 s98, 10
    s_cselect_b32 s49, 10, 0
    s_sub_u32 s98, s98, s49
    s_mov_b32 s48, 6144
    buffer_load_dwordx4 v[196:199], v6, s[20:23], s48 offen offset:0 nt
    s_mov_b32 s48, 6144
    buffer_load_dwordx4 v[200:203], v6, s[20:23], s48 offen offset:128 nt
    s_mov_b32 s48, 6144
    buffer_load_dwordx4 v[204:207], v6, s[20:23], s48 offen offset:256 nt
    s_mov_b32 s48, 6144
    buffer_load_dwordx4 v[208:211], v6, s[20:23], s48 offen offset:3072 nt
    s_mov_b32 s48, 6144
    buffer_load_dwordx4 v[212:215], v6, s[20:23], s48 offen offset:3200 nt
    s_mov_b32 s48, 6144
    buffer_load_dwordx4 v[216:219], v6, s[20:23], s48 offen offset:3328 nt
    s_barrier
    s_mov_b32 s48, 12288
    buffer_load_dwordx4 v[220:223], v6, s[20:23], s48 offen offset:0 nt
    s_mov_b32 s48, 12288
    buffer_load_dwordx4 v[224:227], v6, s[20:23], s48 offen offset:128 nt
    s_mov_b32 s48, 12288
    buffer_load_dwordx4 v[228:231], v6, s[20:23], s48 offen offset:256 nt
    s_mov_b32 s48, 12288
    buffer_load_dwordx4 v[232:235], v6, s[20:23], s48 offen offset:3072 nt
    s_mov_b32 s48, 12288
    buffer_load_dwordx4 v[236:239], v6, s[20:23], s48 offen offset:3200 nt
    s_mov_b32 s48, 12288
    buffer_load_dwordx4 v[240:243], v6, s[20:23], s48 offen offset:3328 nt
    s_waitcnt vmcnt(12)
    s_barrier
    s_getpc_b64 s[48:49]
pc_17:
    s_add_u32 s48, s48, TAIL_BEGIN-pc_17
    s_addc_u32 s49, s49, 0
    s_and_b32 s49, s49, 0xffff
    s_mov_b32 s50, TAIL_END-TAIL_BEGIN
    s_mov_b32 s51, 0x20000
    buffer_load_dword v65, v64, s[48:51], 0 offen
    ds_write_b128 v7, v[100:103] offset:0
    ds_write_b128 v8, v[112:115] offset:1024
    ds_write_b128 v7, v[124:127] offset:2048
    ds_write_b128 v8, v[136:139] offset:3072
    ds_write_b128 v7, v[148:151] offset:4096
    ds_write_b128 v8, v[160:163] offset:5120
    ds_write_b128 v7, v[104:107] offset:6144
    ds_write_b128 v8, v[116:119] offset:7168
    ds_write_b128 v7, v[128:131] offset:8192
    ds_write_b128 v8, v[140:143] offset:9216
    ds_write_b128 v7, v[152:155] offset:10240
    ds_write_b128 v8, v[164:167] offset:11264
    ds_write_b128 v7, v[108:111] offset:12288
    ds_write_b128 v8, v[120:123] offset:13312
    ds_write_b128 v7, v[132:135] offset:14336
    ds_write_b128 v8, v[144:147] offset:15360
    ds_write_b128 v7, v[156:159] offset:16384
    ds_write_b128 v8, v[168:171] offset:17408
    s_waitcnt lgkmcnt(0)
    s_barrier
    s_branch p2b_7
ph_13:
    s_waitcnt lgkmcnt(0)
    s_mov_b32 s8, s70
    s_and_b32 s9, s71, 0xffff
    s_mov_b32 s10, 7864320
    s_mov_b32 s11, 0x20000
    s_mov_b32 s12, s64
    s_and_b32 s13, s65, 0xffff
    s_mov_b32 s14, 983040
    s_mov_b32 s15, 0x20000
    s_mov_b32 s24, s74
    s_and_b32 s25, s75, 0xffff
    s_mov_b32 s26, 268435456
    s_mov_b32 s27, 0x20000
    s_mov_b32 s16, s66
    s_and_b32 s17, s67, 0xffff
    s_mov_b32 s18, 9437184
    s_mov_b32 s19, 0x20000
    s_mov_b32 s20, s68
    s_and_b32 s21, s69, 0xffff
    s_mov_b32 s22, 9437184
    s_mov_b32 s23, 0x20000
    s_mov_b32 s28, s72
    s_and_b32 s29, s73, 0xffff
    s_mov_b32 s30, 7864320
    s_mov_b32 s31, 0x20000
    s_mov_b32 s32, s76
    s_and_b32 s33, s77, 0xffff
    s_mov_b32 s34, 1966080
    s_mov_b32 s35, 0x20000
    s_mov_b32 s4, s78
    s_and_b32 s5, s79, 0xffff
    s_mov_b32 s6, 256
    s_mov_b32 s7, 0x20000
    s_lshl_b32 s48, s38, 2
    s_add_u32 s48, s48, s41
    s_lshl_b32 s48, s48, 13
    s_add_u32 s54, s48, 41943040
    s_lshr_b32 s48, s42, 2
    s_lshl_b32 s55, s39, 1
    s_add_u32 s55, s55, s48
    s_lshl_b32 s48, s43, 2
    s_add_u32 s48, s48, 163328
    v_lshlrev_b32 v34, 2, v0
    v_add_u32 v34, 163584, v34
    v_cmp_eq_u32 vcc, 0, v0
    v_mov_b32 v32, s48
    v_mov_b32 v33, 163344
    v_cndmask_b32 v32, v34, v32, vcc
    v_mov_b32 v34, 0
    ds_write_b32 v32, v34
    s_waitcnt lgkmcnt(0)
    s_lshl_b32 s48, s41, 2
    s_add_u32 s48, s48, s43
    s_lshl_b32 s48, s48, 5
    s_add_u32 s48, s48, s40
    s_mul_i32 s48, s48, 18432
    v_mul_u32_u24 v48, 384, v44
    v_lshl_add_u32 v48, v45, 4, v48
    v_add_u32 v6, s48, v48
    s_mul_i32 s49, s43, 18432
    s_add_u32 s49, s49, 89600
    v_lshlrev_b32 v48, 7, v44
    v_or_b32 v49, 0, v46
    v_xor_b32 v49, v49, v45
    v_lshl_add_u32 v49, v49, 4, v48
    v_add_u32 v7, s49, v49
    v_or_b32 v49, 4, v46
    v_xor_b32 v49, v49, v45
    v_lshl_add_u32 v49, v49, 4, v48
    v_add_u32 v8, s49, v49
    s_mul_i32 s48, s43, 6144
    v_lshlrev_b32 v49, 1, v46
    v_xor_b32 v49, v49, v45
    v_lshl_add_u32 v49, v49, 4, v48
    v_add_u32 v9, s48, v49
    v_mul_u32_u24 v49, 0x5556, v0
    v_lshrrev_b32 v49, 16, v49
    v_mul_u32_u24 v50, 3, v49
    v_sub_u32 v50, v0, v50
    s_mul_i32 s48, s41, 48
    s_mul_i32 s49, s43, 12
    s_add_u32 s48, s48, s49
    s_mul_i32 s49, s55, 768
    s_add_u32 s48, s48, s49
    s_mul_i32 s48, s48, 1280
    s_and_b32 s49, s42, 3
    s_mul_i32 s49, s49, 320
    s_and_b32 s49, s49, 0xffffff80
    s_add_u32 s48, s48, s49
    v_mul_u32_u24 v49, 1280, v49
    v_lshl_add_u32 v49, v50, 7, v49
    v_add_u32 v49, s48, v49
    v_cmp_gt_u32 vcc, 36, v0
    v_mov_b32 v50, 0x7ff00000
    s_nop 0
    v_cndmask_b32 v10, v50, v49, vcc
    v_lshlrev_b32 v64, 7, v0
    s_lshl_b32 s48, s43, 13
    v_add_u32 v64, s48, v64
    s_cmp_ge_u32 s42, 4
    s_mov_b32 s101, 0x4b72e1d8
    s_cmov_b32 s101, 0x87d2b1b4
    s_and_b32 s48, s42, 3
    s_lshl_b32 s48, s48, 3
    s_lshr_b32 s101, s101, s48
    s_mul_i32 s48, s46, 6144
    v_lshlrev_b32 v36, 4, v0
    v_add_u32 v36, s48, v36
    s_and_b32 s48, s42, 3
    s_mul_i32 s48, s48, 320
    s_mul_i32 s49, s46, 20480
    s_add_u32 s48, s48, s49
    s_movk_i32 s49, 3277
    v_add_u32 v48, 0, v0
    v_mul_lo_u32 v49, v48, s49
    v_lshrrev_b32 v49, 16, v49
    v_mul_u32_u24 v50, 20, v49
    v_sub_u32 v50, v48, v50
    v_bfe_u32 v51, v49, 2, 1
    v_lshlrev_b32 v51, 1, v51
    v_xor_b32 v50, v50, v51
    v_mul_u32_u24 v49, 1280, v49
    v_lshl_add_u32 v49, v50, 4, v49
    v_add_u32 v37, s48, v49
    v_add_u32 v48, 64, v0
    v_mul_lo_u32 v49, v48, s49
    v_lshrrev_b32 v49, 16, v49
    v_mul_u32_u24 v50, 20, v49
    v_sub_u32 v50, v48, v50
    v_bfe_u32 v51, v49, 2, 1
    v_lshlrev_b32 v51, 1, v51
    v_xor_b32 v50, v50, v51
    v_mul_u32_u24 v49, 1280, v49
    v_lshl_add_u32 v49, v50, 4, v49
    v_add_u32 v38, s48, v49
    v_add_u32 v48, 128, v0
    v_mul_lo_u32 v49, v48, s49
    v_lshrrev_b32 v49, 16, v49
    v_mul_u32_u24 v50, 20, v49
    v_sub_u32 v50, v48, v50
    v_bfe_u32 v51, v49, 2, 1
    v_lshlrev_b32 v51, 1, v51
    v_xor_b32 v50, v50, v51
    v_mul_u32_u24 v49, 1280, v49
    v_lshl_add_u32 v49, v50, 4, v49
    v_add_u32 v39, s48, v49
    v_add_u32 v48, 192, v0
    v_mul_lo_u32 v49, v48, s49
    v_lshrrev_b32 v49, 16, v49
    v_mul_u32_u24 v50, 20, v49
    v_sub_u32 v50, v48, v50
    v_bfe_u32 v51, v49, 2, 1
    v_lshlrev_b32 v51, 1, v51
    v_xor_b32 v50, v50, v51
    v_mul_u32_u24 v49, 1280, v49
    v_lshl_add_u32 v49, v50, 4, v49
    v_add_u32 v40, s48, v49
    v_add_u32 v48, 256, v0
    v_mul_lo_u32 v49, v48, s49
    v_lshrrev_b32 v49, 16, v49
    v_mul_u32_u24 v50, 20, v49
    v_sub_u32 v50, v48, v50
    v_bfe_u32 v51, v49, 2, 1
    v_lshlrev_b32 v51, 1, v51
    v_xor_b32 v50, v50, v51
    v_mul_u32_u24 v49, 1280, v49
    v_lshl_add_u32 v49, v50, 4, v49
    v_add_u32 v41, s48, v49
    s_lshl_b32 s48, s55, 7
    s_add_u32 s48, s48, s54
    v_and_b32 v42, 15, v0
    v_lshlrev_b32 v42, 2, v42
    v_add_u32 v42, s48, v42
    s_barrier
    s_mul_i32 s49, s98, 786432
    s_add_u32 s50, s49, 196608
    s_add_u32 m0, s59, 98304
    s_nop 0
    buffer_load_dwordx4 v2, s[8:11], s49 offen offset:0 lds
    s_add_u32 m0, s59, 106368
    s_nop 0
    buffer_load_dwordx4 v2, s[8:11], s49 offen offset:128 lds
    s_add_u32 m0, s59, 114432
    s_nop 0
    buffer_load_dwordx4 v2, s[8:11], s49 offen offset:256 lds
    s_add_u32 m0, s59, 99328
    s_nop 0
    buffer_load_dwordx4 v3, s[8:11], s49 offen offset:0 lds
    s_add_u32 m0, s59, 107392
    s_nop 0
    buffer_load_dwordx4 v3, s[8:11], s49 offen offset:128 lds
    s_add_u32 m0, s59, 115456
    s_nop 0
    buffer_load_dwordx4 v3, s[8:11], s49 offen offset:256 lds
    s_add_u32 m0, s59, 100352
    s_nop 0
    buffer_load_dwordx4 v2, s[8:11], s50 offen offset:0 lds
    s_add_u32 m0, s59, 108416
    s_nop 0
    buffer_load_dwordx4 v2, s[8:11], s50 offen offset:128 lds
    s_add_u32 m0, s59, 116480
    s_nop 0
    buffer_load_dwordx4 v2, s[8:11], s50 offen offset:256 lds
    s_add_u32 m0, s59, 101376
    s_nop 0
    buffer_load_dwordx4 v3, s[8:11], s50 offen offset:0 lds
    s_add_u32 m0, s59, 109440
    s_nop 0
    buffer_load_dwordx4 v3, s[8:11], s50 offen offset:128 lds
    s_add_u32 m0, s59, 117504
    s_nop 0
    buffer_load_dwordx4 v3, s[8:11], s50 offen offset:256 lds
    s_lshl_b32 s49, s98, 7
    s_add_u32 m0, s60, 98304
    s_add_u32 s58, s49, 0
    buffer_load_dwordx4 v4, s[12:15], s58 offen lds
    s_add_u32 m0, s60, 99328
    s_add_u32 s58, s49, 0
    buffer_load_dwordx4 v5, s[12:15], s58 offen lds
    s_add_u32 m0, s60, 100352
    s_add_u32 s58, s49, 20480
    buffer_load_dwordx4 v4, s[12:15], s58 offen lds
    s_add_u32 m0, s60, 101376
    s_add_u32 s58, s49, 20480
    buffer_load_dwordx4 v5, s[12:15], s58 offen lds
    s_add_u32 m0, s60, 102400
    s_add_u32 s58, s49, 40960
    buffer_load_dwordx4 v4, s[12:15], s58 offen lds
    s_add_u32 m0, s60, 103424
    s_add_u32 s58, s49, 40960
    buffer_load_dwordx4 v5, s[12:15], s58 offen lds
    s_add_u32 m0, s60, 104448
    s_add_u32 s58, s49, 61440
    buffer_load_dwordx4 v4, s[12:15], s58 offen lds
    s_add_u32 m0, s60, 105472
    s_add_u32 s58, s49, 61440
    buffer_load_dwordx4 v5, s[12:15], s58 offen lds
    s_add_u32 m0, s60, 106496
    s_add_u32 s58, s49, 81920
    buffer_load_dwordx4 v4, s[12:15], s58 offen lds
    s_add_u32 m0, s60, 107520
    s_add_u32 s58, s49, 81920
    buffer_load_dwordx4 v5, s[12:15], s58 offen lds
    s_add_u32 m0, s60, 108544
    s_add_u32 s58, s49, 102400
    buffer_load_dwordx4 v4, s[12:15], s58 offen lds
    s_add_u32 m0, s60, 109568
    s_add_u32 s58, s49, 102400
    buffer_load_dwordx4 v5, s[12:15], s58 offen lds
    s_add_u32 s98, s98, 2
    s_cmp_ge_u32 s98, 10
    s_cselect_b32 s49, 10, 0
    s_sub_u32 s98, s98, s49
    s_barrier
    s_waitcnt vmcnt(0)
    s_barrier
    s_mul_i32 s49, s98, 786432
    s_add_u32 s50, s49, 196608
    s_add_u32 m0, s59, 0
    s_nop 0
    buffer_load_dwordx4 v2, s[8:11], s49 offen offset:0 lds
    s_add_u32 m0, s59, 8064
    s_nop 0
    buffer_load_dwordx4 v2, s[8:11], s49 offen offset:128 lds
    s_add_u32 m0, s59, 16128
    s_nop 0
    buffer_load_dwordx4 v2, s[8:11], s49 offen offset:256 lds
    s_add_u32 m0, s59, 1024
    s_nop 0
    buffer_load_dwordx4 v3, s[8:11], s49 offen offset:0 lds
    s_add_u32 m0, s59, 9088
    s_nop 0
    buffer_load_dwordx4 v3, s[8:11], s49 offen offset:128 lds
    s_add_u32 m0, s59, 17152
    s_nop 0
    buffer_load_dwordx4 v3, s[8:11], s49 offen offset:256 lds
    s_add_u32 m0, s59, 2048
    s_nop 0
    buffer_load_dwordx4 v2, s[8:11], s50 offen offset:0 lds
    s_add_u32 m0, s59, 10112
    s_nop 0
    buffer_load_dwordx4 v2, s[8:11], s50 offen offset:128 lds
    s_add_u32 m0, s59, 18176
    s_nop 0
    buffer_load_dwordx4 v2, s[8:11], s50 offen offset:256 lds
    s_add_u32 m0, s59, 3072
    s_nop 0
    buffer_load_dwordx4 v3, s[8:11], s50 offen offset:0 lds
    s_add_u32 m0, s59, 11136
    s_nop 0
    buffer_load_dwordx4 v3, s[8:11], s50 offen offset:128 lds
    s_add_u32 m0, s59, 19200
    s_nop 0
    buffer_load_dwordx4 v3, s[8:11], s50 offen offset:256 lds
    s_lshl_b32 s49, s98, 7
    s_add_u32 m0, s60, 0
    s_add_u32 s58, s49, 0
    buffer_load_dwordx4 v4, s[12:15], s58 offen lds
    s_add_u32 m0, s60, 1024
    s_add_u32 s58, s49, 0
    buffer_load_dwordx4 v5, s[12:15], s58 offen lds
    s_add_u32 m0, s60, 2048
    s_add_u32 s58, s49, 20480
    buffer_load_dwordx4 v4, s[12:15], s58 offen lds
    s_add_u32 m0, s60, 3072
    s_add_u32 s58, s49, 20480
    buffer_load_dwordx4 v5, s[12:15], s58 offen lds
    s_add_u32 m0, s60, 4096
    s_add_u32 s58, s49, 40960
    buffer_load_dwordx4 v4, s[12:15], s58 offen lds
    s_add_u32 m0, s60, 5120
    s_add_u32 s58, s49, 40960
    buffer_load_dwordx4 v5, s[12:15], s58 offen lds
    s_add_u32 m0, s60, 6144
    s_add_u32 s58, s49, 61440
    buffer_load_dwordx4 v4, s[12:15], s58 offen lds
    s_add_u32 m0, s60, 7168
    s_add_u32 s58, s49, 61440
    buffer_load_dwordx4 v5, s[12:15], s58 offen lds
    s_add_u32 m0, s60, 8192
    s_add_u32 s58, s49, 81920
    buffer_load_dwordx4 v4, s[12:15], s58 offen lds
    s_add_u32 m0, s60, 9216
    s_add_u32 s58, s49, 81920
    buffer_load_dwordx4 v5, s[12:15], s58 offen lds
    s_add_u32 m0, s60, 10240
    s_add_u32 s58, s49, 102400
    buffer_load_dwordx4 v4, s[12:15], s58 offen lds
    s_add_u32 m0, s60, 11264
    s_add_u32 s58, s49, 102400
    buffer_load_dwordx4 v5, s[12:15], s58 offen lds
    s_add_u32 s98, s98, 2
    s_cmp_ge_u32 s98, 10
    s_cselect_b32 s49, 10, 0
    s_sub_u32 s98, s98, s49
    s_barrier
    s_waitcnt vmcnt(0)
    s_barrier
    s_mul_i32 s49, s98, 786432
    s_add_u32 s50, s49, 196608
    s_add_u32 m0, s59, 49152
    s_nop 0
    buffer_load_dwordx4 v2, s[8:11], s49 offen offset:0 lds
    s_add_u32 m0, s59, 57216
    s_nop 0
    buffer_load_dwordx4 v2, s[8:11], s49 offen offset:128 lds
    s_add_u32 m0, s59, 65280
    s_nop 0
    buffer_load_dwordx4 v2, s[8:11], s49 offen offset:256 lds
    s_add_u32 m0, s59, 50176
    s_nop 0
    buffer_load_dwordx4 v3, s[8:11], s49 offen offset:0 lds
    s_add_u32 m0, s59, 58240
    s_nop 0
    buffer_load_dwordx4 v3, s[8:11], s49 offen offset:128 lds
    s_add_u32 m0, s59, 66304
    s_nop 0
    buffer_load_dwordx4 v3, s[8:11], s49 offen offset:256 lds
    s_add_u32 m0, s59, 51200
    s_nop 0
    buffer_load_dwordx4 v2, s[8:11], s50 offen offset:0 lds
    s_add_u32 m0, s59, 59264
    s_nop 0
    buffer_load_dwordx4 v2, s[8:11], s50 offen offset:128 lds
    s_add_u32 m0, s59, 67328
    s_nop 0
    buffer_load_dwordx4 v2, s[8:11], s50 offen offset:256 lds
    s_add_u32 m0, s59, 52224
    s_nop 0
    buffer_load_dwordx4 v3, s[8:11], s50 offen offset:0 lds
    s_add_u32 m0, s59, 60288
    s_nop 0
    buffer_load_dwordx4 v3, s[8:11], s50 offen offset:128 lds
    s_add_u32 m0, s59, 68352
    s_nop 0
    buffer_load_dwordx4 v3, s[8:11], s50 offen offset:256 lds
    s_lshl_b32 s49, s98, 7
    s_add_u32 m0, s60, 49152
    s_add_u32 s58, s49, 0
    buffer_load_dwordx4 v4, s[12:15], s58 offen lds
    s_add_u32 m0, s60, 50176
    s_add_u32 s58, s49, 0
    buffer_load_dwordx4 v5, s[12:15], s58 offen lds
    s_add_u32 m0, s60, 51200
    s_add_u32 s58, s49, 20480
    buffer_load_dwordx4 v4, s[12:15], s58 offen lds
    s_add_u32 m0, s60, 52224
    s_add_u32 s58, s49, 20480
    buffer_load_dwordx4 v5, s[12:15], s58 offen lds
    s_add_u32 m0, s60, 53248
    s_add_u32 s58, s49, 40960
    buffer_load_dwordx4 v4, s[12:15], s58 offen lds
    s_add_u32 m0, s60, 54272
    s_add_u32 s58, s49, 40960
    buffer_load_dwordx4 v5, s[12:15], s58 offen lds
    s_add_u32 m0, s60, 55296
    s_add_u32 s58, s49, 61440
    buffer_load_dwordx4 v4, s[12:15], s58 offen lds
    s_add_u32 m0, s60, 56320
    s_add_u32 s58, s49, 61440
    buffer_load_dwordx4 v5, s[12:15], s58 offen lds
    s_add_u32 m0, s60, 57344
    s_add_u32 s58, s49, 81920
    buffer_load_dwordx4 v4, s[12:15], s58 offen lds
    s_add_u32 m0, s60, 58368
    s_add_u32 s58, s49, 81920
    buffer_load_dwordx4 v5, s[12:15], s58 offen lds
    s_add_u32 m0, s60, 59392
    s_add_u32 s58, s49, 102400
    buffer_load_dwordx4 v4, s[12:15], s58 offen lds
    s_add_u32 m0, s60, 60416
    s_add_u32 s58, s49, 102400
    buffer_load_dwordx4 v5, s[12:15], s58 offen lds
    s_add_u32 s98, s98, 2
    s_cmp_ge_u32 s98, 10
    s_cselect_b32 s49, 10, 0
    s_sub_u32 s98, s98, s49
    s_lshl_b32 s61, s38, 2
    s_add_u32 s61, s61, s41
    s_lshl_b32 s61, s61, 2
    v_mov_b32 v53, 0
    buffer_load_dword v52, v53, s[4:7], s61 offen sc1
    s_mov_b32 s48, 0
    buffer_load_dwordx4 v[100:103], v6, s[16:19], s48 offen offset:0 nt
    s_mov_b32 s48, 0
    buffer_load_dwordx4 v[104:107], v6, s[16:19], s48 offen offset:128 nt
    s_mov_b32 s48, 0
    buffer_load_dwordx4 v[108:111], v6, s[16:19], s48 offen offset:256 nt
    s_mov_b32 s48, 0
    buffer_load_dwordx4 v[112:115], v6, s[16:19], s48 offen offset:3072 nt
    s_mov_b32 s48, 0
    buffer_load_dwordx4 v[116:119], v6, s[16:19], s48 offen offset:3200 nt
    s_mov_b32 s48, 0
    buffer_load_dwordx4 v[120:123], v6, s[16:19], s48 offen offset:3328 nt
    s_mov_b32 s48, 6144
    buffer_load_dwordx4 v[124:127], v6, s[16:19], s48 offen offset:0 nt
    s_mov_b32 s48, 6144
    buffer_load_dwordx4 v[128:131], v6, s[16:19], s48 offen offset:128 nt
    s_mov_b32 s48, 6144
    buffer_load_dwordx4 v[132:135], v6, s[16:19], s48 offen offset:256 nt
    s_barrier
    s_waitcnt vmcnt(9)
    s_cmp_lg_u32 s43, 2
    s_cbranch_scc1 lw2_18
    s_mov_b32 s96, 0
hspoll_19:
    v_readfirstlane_b32 s62, v52
    s_add_u32 s96, s96, 1
    s_cmp_lg_u32 s62, 0
    s_cbranch_scc1 hsok_20
    s_cmp_gt_u32 s96, 1000000
    s_cbranch_scc1 hsok_20
    buffer_load_dword v52, v53, s[4:7], s61 offen sc1
    s_waitcnt vmcnt(0)
    s_branch hspoll_19
hsok_20:
lw2_18:
    s_barrier
    s_mul_i32 s49, s98, 786432
    s_add_u32 s50, s49, 196608
    s_add_u32 m0, s59, 98304
    s_nop 0
    buffer_load_dwordx4 v2, s[8:11], s49 offen offset:0 lds
    s_add_u32 m0, s59, 106368
    s_nop 0
    buffer_load_dwordx4 v2, s[8:11], s49 offen offset:128 lds
    s_add_u32 m0, s59, 114432
    s_nop 0
    buffer_load_dwordx4 v2, s[8:11], s49 offen offset:256 lds
    s_add_u32 m0, s59, 99328
    s_nop 0
    buffer_load_dwordx4 v3, s[8:11], s49 offen offset:0 lds
    s_add_u32 m0, s59, 107392
    s_nop 0
    buffer_load_dwordx4 v3, s[8:11], s49 offen offset:128 lds
    s_add_u32 m0, s59, 115456
    s_nop 0
    buffer_load_dwordx4 v3, s[8:11], s49 offen offset:256 lds
    s_add_u32 m0, s59, 100352
    s_nop 0
    buffer_load_dwordx4 v2, s[8:11], s50 offen offset:0 lds
    s_add_u32 m0, s59, 108416
    s_nop 0
    buffer_load_dwordx4 v2, s[8:11], s50 offen offset:128 lds
    s_add_u32 m0, s59, 116480
    s_nop 0
    buffer_load_dwordx4 v2, s[8:11], s50 offen offset:256 lds
    s_add_u32 m0, s59, 101376
    s_nop 0
    buffer_load_dwordx4 v3, s[8:11], s50 offen offset:0 lds
    s_add_u32 m0, s59, 109440
    s_nop 0
    buffer_load_dwordx4 v3, s[8:11], s50 offen offset:128 lds
    s_add_u32 m0, s59, 117504
    s_nop 0
    buffer_load_dwordx4 v3, s[8:11], s50 offen offset:256 lds
    s_lshl_b32 s49, s98, 7
    s_add_u32 m0, s60, 98304
    s_add_u32 s58, s49, 0
    buffer_load_dwordx4 v4, s[12:15], s58 offen lds
    s_add_u32 m0, s60, 99328
    s_add_u32 s58, s49, 0
    buffer_load_dwordx4 v5, s[12:15], s58 offen lds
    s_add_u32 m0, s60, 100352
    s_add_u32 s58, s49, 20480
    buffer_load_dwordx4 v4, s[12:15], s58 offen lds
    s_add_u32 m0, s60, 101376
    s_add_u32 s58, s49, 20480
    buffer_load_dwordx4 v5, s[12:15], s58 offen lds
    s_add_u32 m0, s60, 102400
    s_add_u32 s58, s49, 40960
    buffer_load_dwordx4 v4, s[12:15], s58 offen lds
    s_add_u32 m0, s60, 103424
    s_add_u32 s58, s49, 40960
    buffer_load_dwordx4 v5, s[12:15], s58 offen lds
    s_add_u32 m0, s60, 104448
    s_add_u32 s58, s49, 61440
    buffer_load_dwordx4 v4, s[12:15], s58 offen lds
    s_add_u32 m0, s60, 105472
    s_add_u32 s58, s49, 61440
    buffer_load_dwordx4 v5, s[12:15], s58 offen lds
    s_add_u32 m0, s60, 106496
    s_add_u32 s58, s49, 81920
    buffer_load_dwordx4 v4, s[12:15], s58 offen lds
    s_add_u32 m0, s60, 107520
    s_add_u32 s58, s49, 81920
    buffer_load_dwordx4 v5, s[12:15], s58 offen lds
    s_add_u32 m0, s60, 108544
    s_add_u32 s58, s49, 102400
    buffer_load_dwordx4 v4, s[12:15], s58 offen lds
    s_add_u32 m0, s60, 109568
    s_add_u32 s58, s49, 102400
    buffer_load_dwordx4 v5, s[12:15], s58 offen lds
    s_add_u32 s98, s98, 2
    s_cmp_ge_u32 s98, 10
    s_cselect_b32 s49, 10, 0
    s_sub_u32 s98, s98, s49
    s_mov_b32 s48, 6144
    buffer_load_dwordx4 v[136:139], v6, s[16:19], s48 offen offset:3072 nt
    s_mov_b32 s48, 6144
    buffer_load_dwordx4 v[140:143], v6, s[16:19], s48 offen offset:3200 nt
    s_mov_b32 s48, 6144
    buffer_load_dwordx4 v[144:147], v6, s[16:19], s48 offen offset:3328 nt
    s_mov_b32 s48, 12288
    buffer_load_dwordx4 v[148:151], v6, s[16:19], s48 offen offset:0 nt
    s_mov_b32 s48, 12288
    buffer_load_dwordx4 v[152:155], v6, s[16:19], s48 offen offset:128 nt
    s_mov_b32 s48, 12288
    buffer_load_dwordx4 v[156:159], v6, s[16:19], s48 offen offset:256 nt
    s_mov_b32 s48, 12288
    buffer_load_dwordx4 v[160:163], v6, s[16:19], s48 offen offset:3072 nt
    s_mov_b32 s48, 12288
    buffer_load_dwordx4 v[164:167], v6, s[16:19], s48 offen offset:3200 nt
    s_mov_b32 s48, 12288
    buffer_load_dwordx4 v[168:171], v6, s[16:19], s48 offen offset:3328 nt
    s_barrier
    s_waitcnt vmcnt(9)
    s_barrier
    s_mul_i32 s49, s98, 786432
    s_add_u32 s50, s49, 196608
    s_add_u32 m0, s59, 0
    s_nop 0
    buffer_load_dwordx4 v2, s[8:11], s49 offen offset:0 lds
    s_add_u32 m0, s59, 8064
    s_nop 0
    buffer_load_dwordx4 v2, s[8:11], s49 offen offset:128 lds
    s_add_u32 m0, s59, 16128
    s_nop 0
    buffer_load_dwordx4 v2, s[8:11], s49 offen offset:256 lds
    s_add_u32 m0, s59, 1024
    s_nop 0
    buffer_load_dwordx4 v3, s[8:11], s49 offen offset:0 lds
    s_add_u32 m0, s59, 9088
    s_nop 0
    buffer_load_dwordx4 v3, s[8:11], s49 offen offset:128 lds
    s_add_u32 m0, s59, 17152
    s_nop 0
    buffer_load_dwordx4 v3, s[8:11], s49 offen offset:256 lds
    s_add_u32 m0, s59, 2048
    s_nop 0
    buffer_load_dwordx4 v2, s[8:11], s50 offen offset:0 lds
    s_add_u32 m0, s59, 10112
    s_nop 0
    buffer_load_dwordx4 v2, s[8:11], s50 offen offset:128 lds
    s_add_u32 m0, s59, 18176
    s_nop 0
    buffer_load_dwordx4 v2, s[8:11], s50 offen offset:256 lds
    s_add_u32 m0, s59, 3072
    s_nop 0
    buffer_load_dwordx4 v3, s[8:11], s50 offen offset:0 lds
    s_add_u32 m0, s59, 11136
    s_nop 0
    buffer_load_dwordx4 v3, s[8:11], s50 offen offset:128 lds
    s_add_u32 m0, s59, 19200
    s_nop 0
    buffer_load_dwordx4 v3, s[8:11], s50 offen offset:256 lds
    s_lshl_b32 s49, s98, 7
    s_add_u32 m0, s60, 0
    s_add_u32 s58, s49, 0
    buffer_load_dwordx4 v4, s[12:15], s58 offen lds
    s_add_u32 m0, s60, 1024
    s_add_u32 s58, s49, 0
    buffer_load_dwordx4 v5, s[12:15], s58 offen lds
    s_add_u32 m0, s60, 2048
    s_add_u32 s58, s49, 20480
    buffer_load_dwordx4 v4, s[12:15], s58 offen lds
    s_add_u32 m0, s60, 3072
    s_add_u32 s58, s49, 20480
    buffer_load_dwordx4 v5, s[12:15], s58 offen lds
    s_add_u32 m0, s60, 4096
    s_add_u32 s58, s49, 40960
    buffer_load_dwordx4 v4, s[12:15], s58 offen lds
    s_add_u32 m0, s60, 5120
    s_add_u32 s58, s49, 40960
    buffer_load_dwordx4 v5, s[12:15], s58 offen lds
    s_add_u32 m0, s60, 6144
    s_add_u32 s58, s49, 61440
    buffer_load_dwordx4 v4, s[12:15], s58 offen lds
    s_add_u32 m0, s60, 7168
    s_add_u32 s58, s49, 61440
    buffer_load_dwordx4 v5, s[12:15], s58 offen lds
    s_add_u32 m0, s60, 8192
    s_add_u32 s58, s49, 81920
    buffer_load_dwordx4 v4, s[12:15], s58 offen lds
    s_add_u32 m0, s60, 9216
    s_add_u32 s58, s49, 81920
    buffer_load_dwordx4 v5, s[12:15], s58 offen lds
    s_add_u32 m0, s60, 10240
    s_add_u32 s58, s49, 102400
    buffer_load_dwordx4 v4, s[12:15], s58 offen lds
    s_add_u32 m0, s60, 11264
    s_add_u32 s58, s49, 102400
    buffer_load_dwordx4 v5, s[12:15], s58 offen lds
    s_add_u32 s98, s98, 2
    s_cmp_ge_u32 s98, 10
    s_cselect_b32 s49, 10, 0
    s_sub_u32 s98, s98, s49
    s_mov_b32 s48, 0
    buffer_load_dwordx4 v[172:175], v6, s[20:23], s48 offen offset:0 nt
    s_mov_b32 s48, 0
    buffer_load_dwordx4 v[176:179], v6, s[20:23], s48 offen offset:128 nt
    s_mov_b32 s48, 0
    buffer_load_dwordx4 v[180:183], v6, s[20:23], s48 offen offset:256 nt
    s_mov_b32 s48, 0
    buffer_load_dwordx4 v[184:187], v6, s[20:23], s48 offen offset:3072 nt
    s_mov_b32 s48, 0
    buffer_load_dwordx4 v[188:191], v6, s[20:23], s48 offen offset:3200 nt
    s_mov_b32 s48, 0
    buffer_load_dwordx4 v[192:195], v6, s[20:23], s48 offen offset:3328 nt
    s_mov_b32 s48, 6144
    buffer_load_dwordx4 v[196:199], v6, s[20:23], s48 offen offset:0 nt
    s_mov_b32 s48, 6144
    buffer_load_dwordx4 v[200:203], v6, s[20:23], s48 offen offset:128 nt
    s_mov_b32 s48, 6144
    buffer_load_dwordx4 v[204:207], v6, s[20:23], s48 offen offset:256 nt
    s_barrier
    s_mov_b32 s48, 6144
    buffer_load_dwordx4 v[208:211], v6, s[20:23], s48 offen offset:3072 nt
    s_mov_b32 s48, 6144
    buffer_load_dwordx4 v[212:215], v6, s[20:23], s48 offen offset:3200 nt
    s_mov_b32 s48, 6144
    buffer_load_dwordx4 v[216:219], v6, s[20:23], s48 offen offset:3328 nt
    s_mov_b32 s48, 12288
    buffer_load_dwordx4 v[220:223], v6, s[20:23], s48 offen offset:0 nt
    s_mov_b32 s48, 12288
    buffer_load_dwordx4 v[224:227], v6, s[20:23], s48 offen offset:128 nt
    s_mov_b32 s48, 12288
    buffer_load_dwordx4 v[228:231], v6, s[20:23], s48 offen offset:256 nt
    s_mov_b32 s48, 12288
    buffer_load_dwordx4 v[232:235], v6, s[20:23], s48 offen offset:3072 nt
    s_mov_b32 s48, 12288
    buffer_load_dwordx4 v[236:239], v6, s[20:23], s48 offen offset:3200 nt
    s_mov_b32 s48, 12288
    buffer_load_dwordx4 v[240:243], v6, s[20:23], s48 offen offset:3328 nt
    s_waitcnt vmcnt(18)
    s_barrier
    s_getpc_b64 s[48:49]
pc_21:
    s_add_u32 s48, s48, TAIL_BEGIN-pc_21
    s_addc_u32 s49, s49, 0
    s_and_b32 s49, s49, 0xffff
    s_mov_b32 s50, TAIL_END-TAIL_BEGIN
    s_mov_b32 s51, 0x20000
    buffer_load_dword v65, v64, s[48:51], 0 offen
    ds_write_b128 v7, v[100:103] offset:0
    ds_write_b128 v8, v[112:115] offset:1024
    ds_write_b128 v7, v[124:127] offset:2048
    ds_write_b128 v8, v[136:139] offset:3072
    ds_write_b128 v7, v[148:151] offset:4096
    ds_write_b128 v8, v[160:163] offset:5120
    ds_write_b128 v7, v[104:107] offset:6144
    ds_write_b128 v8, v[116:119] offset:7168
    ds_write_b128 v7, v[128:131] offset:8192
    ds_write_b128 v8, v[140:143] offset:9216
    ds_write_b128 v7, v[152:155] offset:10240
    ds_write_b128 v8, v[164:167] offset:11264
    ds_write_b128 v7, v[108:111] offset:12288
    ds_write_b128 v8, v[120:123] offset:13312
    ds_write_b128 v7, v[132:135] offset:14336
    ds_write_b128 v8, v[144:147] offset:15360
    ds_write_b128 v7, v[156:159] offset:16384
    ds_write_b128 v8, v[168:171] offset:17408
    s_waitcnt lgkmcnt(0)
    s_barrier
    s_branch p2b_7
TAIL_BEGIN:
p2a_6:
    s_lshl_b32 s48, s36, 2
    s_add_u32 s48, s48, s41
    s_lshl_b32 s48, s48, 3
    s_and_b32 s49, s42, 4
    s_add_u32 s48, s48, s49
    s_mul_i32 s59, s48, 73728
    s_mul_i32 s60, s55, 983040
    s_mul_i32 s61, s46, 6144
    s_add_u32 s61, s61, 0
    s_mul_i32 s62, s46, 5120
    s_add_u32 s62, s62, 101888
    s_bfe_u32 s48, s101, 0x20000
    s_mul_i32 s48, s48, 245760
    buffer_load_dword v66, v10, s[28:31], s48 offen
    s_bfe_u32 s48, s101, 0x20002
    s_mul_i32 s48, s48, 245760
    buffer_load_dword v67, v10, s[28:31], s48 offen
    s_bfe_u32 s48, s101, 0x20004
    s_mul_i32 s48, s48, 245760
    buffer_load_dword v68, v10, s[28:31], s48 offen
    s_mov_b32 s96, 0
lw_22:
    ds_read_b128 v[28:31], v33 offset:0
    s_add_u32 s96, s96, 1
    s_waitcnt lgkmcnt(0)
    v_min3_u32 v28, v28, v29, v30
    v_min_u32 v28, v28, v31
    s_nop 0
    v_readfirstlane_b32 s53, v28
    s_nop 0
    s_cmp_ge_u32 s53, 11
    s_cbranch_scc1 lwok_23
    s_cmp_lt_u32 s96, 2000000
    s_cbranch_scc1 lw_22
lwok_23:
    s_waitcnt vmcnt(3)
    ds_write_b128 v9, v[172:175] offset:0
    ds_write_b128 v9, v[184:187] offset:1024
    ds_write_b128 v9, v[196:199] offset:2048
    ds_write_b128 v9, v[208:211] offset:3072
    ds_write_b128 v9, v[220:223] offset:4096
    ds_write_b128 v9, v[232:235] offset:5120
    v_mov_b32 v34, 12
    ds_write_b32 v32, v34
    ds_write_b128 v9, v[176:179] offset:24576
    ds_write_b128 v9, v[188:191] offset:25600
    ds_write_b128 v9, v[200:203] offset:26624
    ds_write_b128 v9, v[212:215] offset:27648
    ds_write_b128 v9, v[224:227] offset:28672
    ds_write_b128 v9, v[236:239] offset:29696
    v_mov_b32 v34, 13
    ds_write_b32 v32, v34
    ds_write_b128 v9, v[180:183] offset:49152
    ds_write_b128 v9, v[192:195] offset:50176
    ds_write_b128 v9, v[204:207] offset:51200
    ds_write_b128 v9, v[216:219] offset:52224
    ds_write_b128 v9, v[228:231] offset:53248
    ds_write_b128 v9, v[240:243] offset:54272
    v_mov_b32 v34, 14
    ds_write_b32 v32, v34
    s_bfe_u32 s63, s101, 0x20000
    s_mul_i32 s63, s63, 6
    s_add_u32 s63, s63, 0
    s_mul_i32 s48, s63, 40960
    s_add_u32 s48, s48, s60
    s_add_u32 s50, s62, 0
    s_add_u32 m0, s50, 0
    s_nop 0
    buffer_load_dwordx4 v37, s[28:31], s48 offen lds
    s_add_u32 m0, s50, 1024
    s_nop 0
    buffer_load_dwordx4 v38, s[28:31], s48 offen lds
    s_add_u32 m0, s50, 2048
    s_nop 0
    buffer_load_dwordx4 v39, s[28:31], s48 offen lds
    s_add_u32 m0, s50, 3072
    s_nop 0
    buffer_load_dwordx4 v40, s[28:31], s48 offen lds
    s_add_u32 m0, s50, 4096
    s_nop 0
    buffer_load_dwordx4 v41, s[28:31], s48 offen lds
    s_bfe_u32 s63, s101, 0x20000
    s_mul_i32 s63, s63, 6
    s_add_u32 s63, s63, 2
    s_mul_i32 s48, s63, 40960
    s_add_u32 s48, s48, s60
    s_add_u32 s50, s62, 20480
    s_add_u32 m0, s50, 0
    s_nop 0
    buffer_load_dwordx4 v37, s[28:31], s48 offen lds
    s_add_u32 m0, s50, 1024
    s_nop 0
    buffer_load_dwordx4 v38, s[28:31], s48 offen lds
    s_add_u32 m0, s50, 2048
    s_nop 0
    buffer_load_dwordx4 v39, s[28:31], s48 offen lds
    s_add_u32 m0, s50, 3072
    s_nop 0
    buffer_load_dwordx4 v40, s[28:31], s48 offen lds
    s_add_u32 m0, s50, 4096
    s_nop 0
    buffer_load_dwordx4 v41, s[28:31], s48 offen lds
    s_bfe_u32 s63, s101, 0x20000
    s_mul_i32 s63, s63, 6
    s_add_u32 s63, s63, 4
    s_mul_i32 s48, s63, 40960
    s_add_u32 s48, s48, s60
    s_add_u32 s50, s62, 40960
    s_add_u32 m0, s50, 0
    s_nop 0
    buffer_load_dwordx4 v37, s[28:31], s48 offen lds
    s_add_u32 m0, s50, 1024
    s_nop 0
    buffer_load_dwordx4 v38, s[28:31], s48 offen lds
    s_add_u32 m0, s50, 2048
    s_nop 0
    buffer_load_dwordx4 v39, s[28:31], s48 offen lds
    s_add_u32 m0, s50, 3072
    s_nop 0
    buffer_load_dwordx4 v40, s[28:31], s48 offen lds
    s_add_u32 m0, s50, 4096
    s_nop 0
    buffer_load_dwordx4 v41, s[28:31], s48 offen lds
    s_waitcnt vmcnt(0)
    v_mov_b32 v34, 15
    ds_write_b32 v32, v34
    s_mov_b32 s48, 5120
    buffer_load_dword v52, v42, s[24:27], s48 offen sc1
    s_lshl_b32 s48, s36, 2
    s_add_u32 s48, s48, s41
    s_lshl_b32 s48, s48, 3
    s_add_u32 s48, s48, s42
    s_mul_i32 s48, s48, 72
    s_mul_i32 s49, s43, 3
    s_add_u32 s48, s48, s49
    s_lshl_b32 s52, s48, 10
    s_lshl_b32 s48, s55, 7
    s_and_b32 s49, s42, 3
    s_lshl_b32 s49, s49, 4
    s_add_u32 s48, s48, s49
    s_lshl_b32 s49, s43, 2
    s_add_u32 s48, s48, s49
    s_add_u32 s51, s48, s54
    v_lshlrev_b32 v44, 4, v0
    s_mul_i32 s49, s43, 3072
    v_add_u32 v45, s49, v44
    v_mov_b32 v46, 0
    v_mov_b32 v47, 1
    v_mul_u32_u24 v48, 2731, v0
    v_lshrrev_b32 v48, 16, v48
    v_mul_u32_u24 v49, 24, v48
    v_sub_u32 v49, v0, v49
    v_mul_u32_u24 v48, 12288, v48
    v_lshl_add_u32 v48, v49, 7, v48
    v_cmp_gt_u32 vcc, 48, v0
    v_mov_b32 v49, 0x7ff00000
    s_mov_b32 s100, s52
    v_cndmask_b32 v48, v49, v48, vcc
    s_mov_b32 s96, 0
lw_24:
    ds_read_b128 v[28:31], v33 offset:0
    s_add_u32 s96, s96, 1
    s_waitcnt lgkmcnt(0)
    v_min3_u32 v28, v28, v29, v30
    v_min_u32 v28, v28, v31
    s_nop 0
    v_readfirstlane_b32 s53, v28
    s_nop 0
    s_cmp_ge_u32 s53, 14
    s_cbranch_scc1 lwok_25
    s_cmp_lt_u32 s96, 2000000
    s_cbranch_scc1 lw_24
lwok_25:
    ds_read_b128 v[100:103], v45 offset:0
    ds_read_b128 v[104:107], v45 offset:1024
    ds_read_b128 v[108:111], v45 offset:2048
    ds_read_b128 v[112:115], v45 offset:12288
    ds_read_b128 v[116:119], v45 offset:13312
    ds_read_b128 v[120:123], v45 offset:14336
    s_waitcnt lgkmcnt(3)
    buffer_store_dwordx4 v[100:103], v44, s[24:27], s52 offen offset:0 sc1
    buffer_store_dwordx4 v[104:107], v44, s[24:27], s52 offen offset:1024 sc1
    buffer_store_dwordx4 v[108:111], v44, s[24:27], s52 offen offset:2048 sc1
    s_add_u32 s52, s52, 12288
    s_waitcnt lgkmcnt(0)
    buffer_store_dwordx4 v[112:115], v44, s[24:27], s52 offen offset:0 sc1
    buffer_store_dwordx4 v[116:119], v44, s[24:27], s52 offen offset:1024 sc1
    buffer_store_dwordx4 v[120:123], v44, s[24:27], s52 offen offset:2048 sc1
    s_add_u32 s52, s52, 12288
    s_mov_b32 s96, 0
lw_26:
    ds_read_b128 v[28:31], v33 offset:0
    s_add_u32 s96, s96, 1
    s_waitcnt lgkmcnt(0)
    v_min3_u32 v28, v28, v29, v30
    v_min_u32 v28, v28, v31
    s_nop 0
    v_readfirstlane_b32 s53, v28
    s_nop 0
    s_cmp_ge_u32 s53, 16
    s_cbranch_scc1 lwok_27
    s_cmp_lt_u32 s96, 2000000
    s_cbranch_scc1 lw_26
lwok_27:
    ds_read_b128 v[124:127], v45 offset:24576
    ds_read_b128 v[128:131], v45 offset:25600
    ds_read_b128 v[132:135], v45 offset:26624
    ds_read_b128 v[136:139], v45 offset:36864
    ds_read_b128 v[140:143], v45 offset:37888
    ds_read_b128 v[144:147], v45 offset:38912
    s_waitcnt lgkmcnt(3)
    buffer_store_dwordx4 v[124:127], v44, s[24:27], s52 offen offset:0 sc1
    buffer_store_dwordx4 v[128:131], v44, s[24:27], s52 offen offset:1024 sc1
    buffer_store_dwordx4 v[132:135], v44, s[24:27], s52 offen offset:2048 sc1
    s_add_u32 s52, s52, 12288
    s_waitcnt lgkmcnt(0)
    buffer_store_dwordx4 v[136:139], v44, s[24:27], s52 offen offset:0 sc1
    buffer_store_dwordx4 v[140:143], v44, s[24:27], s52 offen offset:1024 sc1
    buffer_store_dwordx4 v[144:147], v44, s[24:27], s52 offen offset:2048 sc1
    s_add_u32 s52, s52, 12288
    s_mov_b32 s96, 0
lw_28:
    ds_read_b128 v[28:31], v33 offset:0
    s_add_u32 s96, s96, 1
    s_waitcnt lgkmcnt(0)
    v_min3_u32 v28, v28, v29, v30
    v_min_u32 v28, v28, v31
    s_nop 0
    v_readfirstlane_b32 s53, v28
    s_nop 0
    s_cmp_ge_u32 s53, 17
    s_cbranch_scc1 lwok_29
    s_cmp_lt_u32 s96, 2000000
    s_cbranch_scc1 lw_28
lwok_29:
    ds_read_b128 v[148:151], v45 offset:49152
    ds_read_b128 v[152:155], v45 offset:50176
    ds_read_b128 v[156:159], v45 offset:51200
    ds_read_b128 v[160:163], v45 offset:61440
    ds_read_b128 v[164:167], v45 offset:62464
    ds_read_b128 v[168:171], v45 offset:63488
    s_waitcnt lgkmcnt(3)
    buffer_store_dwordx4 v[148:151], v44, s[24:27], s52 offen offset:0 sc1
    buffer_store_dwordx4 v[152:155], v44, s[24:27], s52 offen offset:1024 sc1
    buffer_store_dwordx4 v[156:159], v44, s[24:27], s52 offen offset:2048 sc1
    s_add_u32 s52, s52, 12288
    s_waitcnt lgkmcnt(0)
    buffer_store_dwordx4 v[160:163], v44, s[24:27], s52 offen offset:0 sc1
    buffer_store_dwordx4 v[164:167], v44, s[24:27], s52 offen offset:1024 sc1
    buffer_store_dwordx4 v[168:171], v44, s[24:27], s52 offen offset:2048 sc1
    s_add_u32 s52, s52, 12288
    s_barrier
    s_bfe_u32 s63, s101, 0x20002
    s_mul_i32 s63, s63, 6
    s_add_u32 s63, s63, 0
    s_mul_i32 s48, s63, 40960
    s_add_u32 s48, s48, s60
    s_add_u32 s50, s62, 0
    s_add_u32 m0, s50, 0
    s_nop 0
    buffer_load_dwordx4 v37, s[28:31], s48 offen lds
    s_add_u32 m0, s50, 1024
    s_nop 0
    buffer_load_dwordx4 v38, s[28:31], s48 offen lds
    s_add_u32 m0, s50, 2048
    s_nop 0
    buffer_load_dwordx4 v39, s[28:31], s48 offen lds
    s_add_u32 m0, s50, 3072
    s_nop 0
    buffer_load_dwordx4 v40, s[28:31], s48 offen lds
    s_add_u32 m0, s50, 4096
    s_nop 0
    buffer_load_dwordx4 v41, s[28:31], s48 offen lds
    s_bfe_u32 s63, s101, 0x20002
    s_mul_i32 s63, s63, 6
    s_add_u32 s63, s63, 2
    s_mul_i32 s48, s63, 40960
    s_add_u32 s48, s48, s60
    s_add_u32 s50, s62, 20480
    s_add_u32 m0, s50, 0
    s_nop 0
    buffer_load_dwordx4 v37, s[28:31], s48 offen lds
    s_add_u32 m0, s50, 1024
    s_nop 0
    buffer_load_dwordx4 v38, s[28:31], s48 offen lds
    s_add_u32 m0, s50, 2048
    s_nop 0
    buffer_load_dwordx4 v39, s[28:31], s48 offen lds
    s_add_u32 m0, s50, 3072
    s_nop 0
    buffer_load_dwordx4 v40, s[28:31], s48 offen lds
    s_add_u32 m0, s50, 4096
    s_nop 0
    buffer_load_dwordx4 v41, s[28:31], s48 offen lds
    s_add_u32 s52, s51, 5120
    s_mov_b64 exec, 1
    s_waitcnt vmcnt(10)
    buffer_store_dword v47, v46, s[24:27], s52 offen
    buffer_store_dword v47, v46, s[24:27], s51 offen sc1
    s_mov_b64 exec, -1
    s_barrier
    s_bfe_u32 s63, s101, 0x20002
    s_mul_i32 s63, s63, 6
    s_add_u32 s63, s63, 4
    s_mul_i32 s48, s63, 40960
    s_add_u32 s48, s48, s60
    s_add_u32 s50, s62, 40960
    s_add_u32 m0, s50, 0
    s_nop 0
    buffer_load_dwordx4 v37, s[28:31], s48 offen lds
    s_add_u32 m0, s50, 1024
    s_nop 0
    buffer_load_dwordx4 v38, s[28:31], s48 offen lds
    s_add_u32 m0, s50, 2048
    s_nop 0
    buffer_load_dwordx4 v39, s[28:31], s48 offen lds
    s_add_u32 m0, s50, 3072
    s_nop 0
    buffer_load_dwordx4 v40, s[28:31], s48 offen lds
    s_add_u32 m0, s50, 4096
    s_nop 0
    buffer_load_dwordx4 v41, s[28:31], s48 offen lds
    s_bfe_u32 s51, s101, 0x20002
    s_lshl_b32 s51, s51, 2
    s_lshl_b32 s51, 15, s51
    s_mov_b32 s96, 0
f1poll_30:
    s_and_b32 s48, s96, 7
    s_cmp_eq_u32 s48, 7
    s_cselect_b32 s48, 0, 5120
    buffer_load_dword v52, v42, s[24:27], s48 offen sc1
    s_waitcnt vmcnt(0)
    v_cmp_ne_u32 vcc, 0, v52
    s_add_u32 s96, s96, 1
    s_nop 2
    s_mov_b32 s52, vcc_lo
    s_and_b32 s48, s52, s51
    s_cmp_eq_u32 s48, s51
    s_cbranch_scc1 f1ok_31
    s_cmp_lt_u32 s96, 1000000
    s_cbranch_scc1 f1poll_30
f1ok_31:
    s_bfe_u32 s63, s101, 0x20002
    s_mul_i32 s63, s63, 6
    s_add_u32 s63, s63, 0
    s_mul_i32 s48, s63, 12288
    s_add_u32 s48, s48, s59
    s_add_u32 s49, s48, 4096
    s_add_u32 m0, s61, 0
    s_nop 0
    buffer_load_dwordx4 v36, s[24:27], s48 offen offset:0 sc1 lds
    buffer_load_dwordx4 v36, s[24:27], s48 offen offset:1024 sc1 lds
    buffer_load_dwordx4 v36, s[24:27], s48 offen offset:2048 sc1 lds
    buffer_load_dwordx4 v36, s[24:27], s48 offen offset:3072 sc1 lds
    s_add_u32 m0, m0, 4096
    s_nop 0
    buffer_load_dwordx4 v36, s[24:27], s49 offen offset:0 sc1 lds
    buffer_load_dwordx4 v36, s[24:27], s49 offen offset:1024 sc1 lds
    s_bfe_u32 s63, s101, 0x20002
    s_mul_i32 s63, s63, 6
    s_add_u32 s63, s63, 2
    s_mul_i32 s48, s63, 12288
    s_add_u32 s48, s48, s59
    s_add_u32 s49, s48, 4096
    s_add_u32 m0, s61, 24576
    s_nop 0
    buffer_load_dwordx4 v36, s[24:27], s48 offen offset:0 sc1 lds
    buffer_load_dwordx4 v36, s[24:27], s48 offen offset:1024 sc1 lds
    buffer_load_dwordx4 v36, s[24:27], s48 offen offset:2048 sc1 lds
    buffer_load_dwordx4 v36, s[24:27], s48 offen offset:3072 sc1 lds
    s_add_u32 m0, m0, 4096
    s_nop 0
    buffer_load_dwordx4 v36, s[24:27], s49 offen offset:0 sc1 lds
    buffer_load_dwordx4 v36, s[24:27], s49 offen offset:1024 sc1 lds
    s_waitcnt vmcnt(6)
    s_barrier
    s_barrier
    s_bfe_u32 s63, s101, 0x20002
    s_mul_i32 s63, s63, 6
    s_add_u32 s63, s63, 4
    s_mul_i32 s48, s63, 12288
    s_add_u32 s48, s48, s59
    s_add_u32 s49, s48, 4096
    s_add_u32 m0, s61, 49152
    s_nop 0
    buffer_load_dwordx4 v36, s[24:27], s48 offen offset:0 sc1 lds
    buffer_load_dwordx4 v36, s[24:27], s48 offen offset:1024 sc1 lds
    buffer_load_dwordx4 v36, s[24:27], s48 offen offset:2048 sc1 lds
    buffer_load_dwordx4 v36, s[24:27], s48 offen offset:3072 sc1 lds
    s_add_u32 m0, m0, 4096
    s_nop 0
    buffer_load_dwordx4 v36, s[24:27], s49 offen offset:0 sc1 lds
    buffer_load_dwordx4 v36, s[24:27], s49 offen offset:1024 sc1 lds
    s_waitcnt vmcnt(6)
    s_barrier
    s_barrier
    s_bfe_u32 s51, s101, 0x20004
    s_lshl_b32 s51, s51, 2
    s_lshl_b32 s51, 15, s51
    s_and_b32 s48, s52, s51
    s_cmp_eq_u32 s48, s51
    s_cbranch_scc1 f1ok_33
    s_mov_b32 s96, 0
f1poll_32:
    s_and_b32 s48, s96, 7
    s_cmp_eq_u32 s48, 7
    s_cselect_b32 s48, 0, 5120
    buffer_load_dword v52, v42, s[24:27], s48 offen sc1
    s_waitcnt vmcnt(0)
    v_cmp_ne_u32 vcc, 0, v52
    s_add_u32 s96, s96, 1
    s_nop 2
    s_mov_b32 s52, vcc_lo
    s_and_b32 s48, s52, s51
    s_cmp_eq_u32 s48, s51
    s_cbranch_scc1 f1ok_33
    s_cmp_lt_u32 s96, 1000000
    s_cbranch_scc1 f1poll_32
f1ok_33:
    s_bfe_u32 s63, s101, 0x20004
    s_mul_i32 s63, s63, 6
    s_add_u32 s63, s63, 0
    s_mul_i32 s48, s63, 12288
    s_add_u32 s48, s48, s59
    s_add_u32 s49, s48, 4096
    s_add_u32 m0, s61, 0
    s_nop 0
    buffer_load_dwordx4 v36, s[24:27], s48 offen offset:0 sc1 lds
    buffer_load_dwordx4 v36, s[24:27], s48 offen offset:1024 sc1 lds
    buffer_load_dwordx4 v36, s[24:27], s48 offen offset:2048 sc1 lds
    buffer_load_dwordx4 v36, s[24:27], s48 offen offset:3072 sc1 lds
    s_add_u32 m0, m0, 4096
    s_nop 0
    buffer_load_dwordx4 v36, s[24:27], s49 offen offset:0 sc1 lds
    buffer_load_dwordx4 v36, s[24:27], s49 offen offset:1024 sc1 lds
    s_mul_i32 s48, s63, 40960
    s_add_u32 s48, s48, s60
    s_add_u32 s50, s62, 0
    s_add_u32 m0, s50, 0
    s_nop 0
    buffer_load_dwordx4 v37, s[28:31], s48 offen lds
    s_add_u32 m0, s50, 1024
    s_nop 0
    buffer_load_dwordx4 v38, s[28:31], s48 offen lds
    s_add_u32 m0, s50, 2048
    s_nop 0
    buffer_load_dwordx4 v39, s[28:31], s48 offen lds
    s_add_u32 m0, s50, 3072
    s_nop 0
    buffer_load_dwordx4 v40, s[28:31], s48 offen lds
    s_add_u32 m0, s50, 4096
    s_nop 0
    buffer_load_dwordx4 v41, s[28:31], s48 offen lds
    s_bfe_u32 s48, s101, 0x20006
    s_mul_i32 s48, s48, 245760
    buffer_load_dword v69, v10, s[28:31], s48 offen
    s_add_u32 s48, s48, 30720
    buffer_load_dword v73, v10, s[28:31], s48 offen
    s_waitcnt vmcnt(13)
    s_barrier
    s_barrier
    s_bfe_u32 s63, s101, 0x20004
    s_mul_i32 s63, s63, 6
    s_add_u32 s63, s63, 2
    s_mul_i32 s48, s63, 12288
    s_add_u32 s48, s48, s59
    s_add_u32 s49, s48, 4096
    s_add_u32 m0, s61, 24576
    s_nop 0
    buffer_load_dwordx4 v36, s[24:27], s48 offen offset:0 sc1 lds
    buffer_load_dwordx4 v36, s[24:27], s48 offen offset:1024 sc1 lds
    buffer_load_dwordx4 v36, s[24:27], s48 offen offset:2048 sc1 lds
    buffer_load_dwordx4 v36, s[24:27], s48 offen offset:3072 sc1 lds
    s_add_u32 m0, m0, 4096
    s_nop 0
    buffer_load_dwordx4 v36, s[24:27], s49 offen offset:0 sc1 lds
    buffer_load_dwordx4 v36, s[24:27], s49 offen offset:1024 sc1 lds
    s_mul_i32 s48, s63, 40960
    s_add_u32 s48, s48, s60
    s_add_u32 s50, s62, 20480
    s_add_u32 m0, s50, 0
    s_nop 0
    buffer_load_dwordx4 v37, s[28:31], s48 offen lds
    s_add_u32 m0, s50, 1024
    s_nop 0
    buffer_load_dwordx4 v38, s[28:31], s48 offen lds
    s_add_u32 m0, s50, 2048
    s_nop 0
    buffer_load_dwordx4 v39, s[28:31], s48 offen lds
    s_add_u32 m0, s50, 3072
    s_nop 0
    buffer_load_dwordx4 v40, s[28:31], s48 offen lds
    s_add_u32 m0, s50, 4096
    s_nop 0
    buffer_load_dwordx4 v41, s[28:31], s48 offen lds
    s_bfe_u32 s63, s101, 0x20004
    s_mul_i32 s63, s63, 6
    s_add_u32 s63, s63, 4
    s_mul_i32 s48, s63, 12288
    s_add_u32 s48, s48, s59
    s_add_u32 s49, s48, 4096
    s_add_u32 m0, s61, 49152
    s_nop 0
    buffer_load_dwordx4 v36, s[24:27], s48 offen offset:0 sc1 lds
    buffer_load_dwordx4 v36, s[24:27], s48 offen offset:1024 sc1 lds
    buffer_load_dwordx4 v36, s[24:27], s48 offen offset:2048 sc1 lds
    buffer_load_dwordx4 v36, s[24:27], s48 offen offset:3072 sc1 lds
    s_add_u32 m0, m0, 4096
    s_nop 0
    buffer_load_dwordx4 v36, s[24:27], s49 offen offset:0 sc1 lds
    buffer_load_dwordx4 v36, s[24:27], s49 offen offset:1024 sc1 lds
    s_mul_i32 s48, s63, 40960
    s_add_u32 s48, s48, s60
    s_add_u32 s50, s62, 40960
    s_add_u32 m0, s50, 0
    s_nop 0
    buffer_load_dwordx4 v37, s[28:31], s48 offen lds
    s_add_u32 m0, s50, 1024
    s_nop 0
    buffer_load_dwordx4 v38, s[28:31], s48 offen lds
    s_add_u32 m0, s50, 2048
    s_nop 0
    buffer_load_dwordx4 v39, s[28:31], s48 offen lds
    s_add_u32 m0, s50, 3072
    s_nop 0
    buffer_load_dwordx4 v40, s[28:31], s48 offen lds
    s_add_u32 m0, s50, 4096
    s_nop 0
    buffer_load_dwordx4 v41, s[28:31], s48 offen lds
    s_waitcnt vmcnt(22)
    s_barrier
    s_barrier
    s_bfe_u32 s51, s101, 0x20006
    s_lshl_b32 s51, s51, 2
    s_lshl_b32 s51, 15, s51
    s_and_b32 s48, s52, s51
    s_cmp_eq_u32 s48, s51
    s_cbranch_scc1 f1ok_35
    s_mov_b32 s96, 0
f1poll_34:
    s_and_b32 s48, s96, 7
    s_cmp_eq_u32 s48, 7
    s_cselect_b32 s48, 0, 5120
    buffer_load_dword v52, v42, s[24:27], s48 offen sc1
    s_waitcnt vmcnt(0)
    v_cmp_ne_u32 vcc, 0, v52
    s_add_u32 s96, s96, 1
    s_nop 2
    s_mov_b32 s52, vcc_lo
    s_and_b32 s48, s52, s51
    s_cmp_eq_u32 s48, s51
    s_cbranch_scc1 f1ok_35
    s_cmp_lt_u32 s96, 1000000
    s_cbranch_scc1 f1poll_34
f1ok_35:
    s_bfe_u32 s63, s101, 0x20006
    s_mul_i32 s63, s63, 6
    s_add_u32 s63, s63, 0
    s_mul_i32 s48, s63, 12288
    s_add_u32 s48, s48, s59
    s_add_u32 s49, s48, 4096
    s_add_u32 m0, s61, 0
    s_nop 0
    buffer_load_dwordx4 v36, s[24:27], s48 offen offset:0 sc1 lds
    buffer_load_dwordx4 v36, s[24:27], s48 offen offset:1024 sc1 lds
    buffer_load_dwordx4 v36, s[24:27], s48 offen offset:2048 sc1 lds
    buffer_load_dwordx4 v36, s[24:27], s48 offen offset:3072 sc1 lds
    s_add_u32 m0, m0, 4096
    s_nop 0
    buffer_load_dwordx4 v36, s[24:27], s49 offen offset:0 sc1 lds
    buffer_load_dwordx4 v36, s[24:27], s49 offen offset:1024 sc1 lds
    s_mul_i32 s48, s63, 40960
    s_add_u32 s48, s48, s60
    s_add_u32 s50, s62, 0
    s_add_u32 m0, s50, 0
    s_nop 0
    buffer_load_dwordx4 v37, s[28:31], s48 offen lds
    s_add_u32 m0, s50, 1024
    s_nop 0
    buffer_load_dwordx4 v38, s[28:31], s48 offen lds
    s_add_u32 m0, s50, 2048
    s_nop 0
    buffer_load_dwordx4 v39, s[28:31], s48 offen lds
    s_add_u32 m0, s50, 3072
    s_nop 0
    buffer_load_dwordx4 v40, s[28:31], s48 offen lds
    s_add_u32 m0, s50, 4096
    s_nop 0
    buffer_load_dwordx4 v41, s[28:31], s48 offen lds
    s_waitcnt vmcnt(22)
    s_barrier
    s_barrier
    s_bfe_u32 s63, s101, 0x20006
    s_mul_i32 s63, s63, 6
    s_add_u32 s63, s63, 2
    s_mul_i32 s48, s63, 12288
    s_add_u32 s48, s48, s59
    s_add_u32 s49, s48, 4096
    s_add_u32 m0, s61, 24576
    s_nop 0
    buffer_load_dwordx4 v36, s[24:27], s48 offen offset:0 sc1 lds
    buffer_load_dwordx4 v36, s[24:27], s48 offen offset:1024 sc1 lds
    buffer_load_dwordx4 v36, s[24:27], s48 offen offset:2048 sc1 lds
    buffer_load_dwordx4 v36, s[24:27], s48 offen offset:3072 sc1 lds
    s_add_u32 m0, m0, 4096
    s_nop 0
    buffer_load_dwordx4 v36, s[24:27], s49 offen offset:0 sc1 lds
    buffer_load_dwordx4 v36, s[24:27], s49 offen offset:1024 sc1 lds
    s_mul_i32 s48, s63, 40960
    s_add_u32 s48, s48, s60
    s_add_u32 s50, s62, 20480
    s_add_u32 m0, s50, 0
    s_nop 0
    buffer_load_dwordx4 v37, s[28:31], s48 offen lds
    s_add_u32 m0, s50, 1024
    s_nop 0
    buffer_load_dwordx4 v38, s[28:31], s48 offen lds
    s_add_u32 m0, s50, 2048
    s_nop 0
    buffer_load_dwordx4 v39, s[28:31], s48 offen lds
    s_add_u32 m0, s50, 3072
    s_nop 0
    buffer_load_dwordx4 v40, s[28:31], s48 offen lds
    s_add_u32 m0, s50, 4096
    s_nop 0
    buffer_load_dwordx4 v41, s[28:31], s48 offen lds
    s_waitcnt vmcnt(22)
    s_barrier
    s_barrier
    s_bfe_u32 s63, s101, 0x20006
    s_mul_i32 s63, s63, 6
    s_add_u32 s63, s63, 4
    s_mul_i32 s48, s63, 12288
    s_add_u32 s48, s48, s59
    s_add_u32 s49, s48, 4096
    s_add_u32 m0, s61, 49152
    s_nop 0
    buffer_load_dwordx4 v36, s[24:27], s48 offen offset:0 sc1 lds
    buffer_load_dwordx4 v36, s[24:27], s48 offen offset:1024 sc1 lds
    buffer_load_dwordx4 v36, s[24:27], s48 offen offset:2048 sc1 lds
    buffer_load_dwordx4 v36, s[24:27], s48 offen offset:3072 sc1 lds
    s_add_u32 m0, m0, 4096
    s_nop 0
    buffer_load_dwordx4 v36, s[24:27], s49 offen offset:0 sc1 lds
    buffer_load_dwordx4 v36, s[24:27], s49 offen offset:1024 sc1 lds
    s_mul_i32 s48, s63, 40960
    s_add_u32 s48, s48, s60
    s_add_u32 s50, s62, 40960
    s_add_u32 m0, s50, 0
    s_nop 0
    buffer_load_dwordx4 v37, s[28:31], s48 offen lds
    s_add_u32 m0, s50, 1024
    s_nop 0
    buffer_load_dwordx4 v38, s[28:31], s48 offen lds
    s_add_u32 m0, s50, 2048
    s_nop 0
    buffer_load_dwordx4 v39, s[28:31], s48 offen lds
    s_add_u32 m0, s50, 3072
    s_nop 0
    buffer_load_dwordx4 v40, s[28:31], s48 offen lds
    s_add_u32 m0, s50, 4096
    s_nop 0
    buffer_load_dwordx4 v41, s[28:31], s48 offen lds
    s_waitcnt vmcnt(22)
    s_barrier
    s_barrier
    s_waitcnt vmcnt(11)
    s_barrier
    s_barrier
    s_waitcnt vmcnt(0)
    s_barrier
    s_barrier
    s_barrier
    s_branch ldone_5
p2b_7:
    s_lshl_b32 s48, s36, 2
    s_add_u32 s48, s48, s41
    s_lshl_b32 s48, s48, 3
    s_and_b32 s49, s42, 4
    s_add_u32 s48, s48, s49
    s_mul_i32 s59, s48, 73728
    s_mul_i32 s60, s55, 983040
    s_mul_i32 s61, s46, 6144
    s_add_u32 s61, s61, 0
    s_mul_i32 s62, s46, 5120
    s_add_u32 s62, s62, 101888
    s_bfe_u32 s48, s101, 0x20000
    s_mul_i32 s48, s48, 245760
    buffer_load_dword v66, v10, s[28:31], s48 offen
    s_bfe_u32 s48, s101, 0x20002
    s_mul_i32 s48, s48, 245760
    buffer_load_dword v67, v10, s[28:31], s48 offen
    s_bfe_u32 s48, s101, 0x20004
    s_mul_i32 s48, s48, 245760
    buffer_load_dword v68, v10, s[28:31], s48 offen
    s_mov_b32 s96, 0
lw_36:
    ds_read_b128 v[28:31], v33 offset:0
    s_add_u32 s96, s96, 1
    s_waitcnt lgkmcnt(0)
    v_min3_u32 v28, v28, v29, v30
    v_min_u32 v28, v28, v31
    s_nop 0
    v_readfirstlane_b32 s53, v28
    s_nop 0
    s_cmp_ge_u32 s53, 11
    s_cbranch_scc1 lwok_37
    s_cmp_lt_u32 s96, 2000000
    s_cbranch_scc1 lw_36
lwok_37:
    s_waitcnt vmcnt(3)
    ds_write_b128 v9, v[172:175] offset:0
    ds_write_b128 v9, v[184:187] offset:1024
    ds_write_b128 v9, v[196:199] offset:2048
    ds_write_b128 v9, v[208:211] offset:3072
    ds_write_b128 v9, v[220:223] offset:4096
    ds_write_b128 v9, v[232:235] offset:5120
    v_mov_b32 v34, 12
    ds_write_b32 v32, v34
    ds_write_b128 v9, v[176:179] offset:24576
    ds_write_b128 v9, v[188:191] offset:25600
    ds_write_b128 v9, v[200:203] offset:26624
    ds_write_b128 v9, v[212:215] offset:27648
    ds_write_b128 v9, v[224:227] offset:28672
    ds_write_b128 v9, v[236:239] offset:29696
    v_mov_b32 v34, 13
    ds_write_b32 v32, v34
    ds_write_b128 v9, v[180:183] offset:49152
    ds_write_b128 v9, v[192:195] offset:50176
    ds_write_b128 v9, v[204:207] offset:51200
    ds_write_b128 v9, v[216:219] offset:52224
    ds_write_b128 v9, v[228:231] offset:53248
    ds_write_b128 v9, v[240:243] offset:54272
    v_mov_b32 v34, 14
    ds_write_b32 v32, v34
    s_bfe_u32 s63, s101, 0x20000
    s_mul_i32 s63, s63, 6
    s_add_u32 s63, s63, 1
    s_mul_i32 s48, s63, 40960
    s_add_u32 s48, s48, s60
    s_add_u32 s50, s62, 10240
    s_add_u32 m0, s50, 0
    s_nop 0
    buffer_load_dwordx4 v37, s[28:31], s48 offen lds
    s_add_u32 m0, s50, 1024
    s_nop 0
    buffer_load_dwordx4 v38, s[28:31], s48 offen lds
    s_add_u32 m0, s50, 2048
    s_nop 0
    buffer_load_dwordx4 v39, s[28:31], s48 offen lds
    s_add_u32 m0, s50, 3072
    s_nop 0
    buffer_load_dwordx4 v40, s[28:31], s48 offen lds
    s_add_u32 m0, s50, 4096
    s_nop 0
    buffer_load_dwordx4 v41, s[28:31], s48 offen lds
    s_bfe_u32 s63, s101, 0x20000
    s_mul_i32 s63, s63, 6
    s_add_u32 s63, s63, 3
    s_mul_i32 s48, s63, 40960
    s_add_u32 s48, s48, s60
    s_add_u32 s50, s62, 30720
    s_add_u32 m0, s50, 0
    s_nop 0
    buffer_load_dwordx4 v37, s[28:31], s48 offen lds
    s_add_u32 m0, s50, 1024
    s_nop 0
    buffer_load_dwordx4 v38, s[28:31], s48 offen lds
    s_add_u32 m0, s50, 2048
    s_nop 0
    buffer_load_dwordx4 v39, s[28:31], s48 offen lds
    s_add_u32 m0, s50, 3072
    s_nop 0
    buffer_load_dwordx4 v40, s[28:31], s48 offen lds
    s_add_u32 m0, s50, 4096
    s_nop 0
    buffer_load_dwordx4 v41, s[28:31], s48 offen lds
    s_bfe_u32 s63, s101, 0x20000
    s_mul_i32 s63, s63, 6
    s_add_u32 s63, s63, 5
    s_mul_i32 s48, s63, 40960
    s_add_u32 s48, s48, s60
    s_add_u32 s50, s62, 51200
    s_add_u32 m0, s50, 0
    s_nop 0
    buffer_load_dwordx4 v37, s[28:31], s48 offen lds
    s_add_u32 m0, s50, 1024
    s_nop 0
    buffer_load_dwordx4 v38, s[28:31], s48 offen lds
    s_add_u32 m0, s50, 2048
    s_nop 0
    buffer_load_dwordx4 v39, s[28:31], s48 offen lds
    s_add_u32 m0, s50, 3072
    s_nop 0
    buffer_load_dwordx4 v40, s[28:31], s48 offen lds
    s_add_u32 m0, s50, 4096
    s_nop 0
    buffer_load_dwordx4 v41, s[28:31], s48 offen lds
    s_waitcnt vmcnt(0)
    v_mov_b32 v34, 15
    ds_write_b32 v32, v34
    s_mov_b32 s48, 5120
    buffer_load_dword v52, v42, s[24:27], s48 offen sc1
    s_lshl_b32 s48, s36, 2
    s_add_u32 s48, s48, s41
    s_lshl_b32 s48, s48, 3
    s_add_u32 s48, s48, s42
    s_mul_i32 s48, s48, 72
    s_mul_i32 s49, s43, 3
    s_add_u32 s48, s48, s49
    s_lshl_b32 s52, s48, 10
    s_lshl_b32 s48, s55, 7
    s_and_b32 s49, s42, 3
    s_lshl_b32 s49, s49, 4
    s_add_u32 s48, s48, s49
    s_lshl_b32 s49, s43, 2
    s_add_u32 s48, s48, s49
    s_add_u32 s51, s48, s54
    v_lshlrev_b32 v44, 4, v0
    s_mul_i32 s49, s43, 3072
    v_add_u32 v45, s49, v44
    v_mov_b32 v46, 0
    v_mov_b32 v47, 1
    v_mul_u32_u24 v48, 2731, v0
    v_lshrrev_b32 v48, 16, v48
    v_mul_u32_u24 v49, 24, v48
    v_sub_u32 v49, v0, v49
    v_mul_u32_u24 v48, 12288, v48
    v_lshl_add_u32 v48, v49, 7, v48
    v_cmp_gt_u32 vcc, 48, v0
    v_mov_b32 v49, 0x7ff00000
    s_mov_b32 s100, s52
    v_cndmask_b32 v48, v49, v48, vcc
    s_mov_b32 s96, 0
lw_38:
    ds_read_b128 v[28:31], v33 offset:0
    s_add_u32 s96, s96, 1
    s_waitcnt lgkmcnt(0)
    v_min3_u32 v28, v28, v29, v30
    v_min_u32 v28, v28, v31
    s_nop 0
    v_readfirstlane_b32 s53, v28
    s_nop 0
    s_cmp_ge_u32 s53, 14
    s_cbranch_scc1 lwok_39
    s_cmp_lt_u32 s96, 2000000
    s_cbranch_scc1 lw_38
lwok_39:
    ds_read_b128 v[100:103], v45 offset:0
    ds_read_b128 v[104:107], v45 offset:1024
    ds_read_b128 v[108:111], v45 offset:2048
    ds_read_b128 v[112:115], v45 offset:12288
    ds_read_b128 v[116:119], v45 offset:13312
    ds_read_b128 v[120:123], v45 offset:14336
    s_waitcnt lgkmcnt(3)
    buffer_store_dwordx4 v[100:103], v44, s[24:27], s52 offen offset:0 sc1
    buffer_store_dwordx4 v[104:107], v44, s[24:27], s52 offen offset:1024 sc1
    buffer_store_dwordx4 v[108:111], v44, s[24:27], s52 offen offset:2048 sc1
    s_add_u32 s52, s52, 12288
    s_waitcnt lgkmcnt(0)
    buffer_store_dwordx4 v[112:115], v44, s[24:27], s52 offen offset:0 sc1
    buffer_store_dwordx4 v[116:119], v44, s[24:27], s52 offen offset:1024 sc1
    buffer_store_dwordx4 v[120:123], v44, s[24:27], s52 offen offset:2048 sc1
    s_add_u32 s52, s52, 12288
    s_mov_b32 s96, 0
lw_40:
    ds_read_b128 v[28:31], v33 offset:0
    s_add_u32 s96, s96, 1
    s_waitcnt lgkmcnt(0)
    v_min3_u32 v28, v28, v29, v30
    v_min_u32 v28, v28, v31
    s_nop 0
    v_readfirstlane_b32 s53, v28
    s_nop 0
    s_cmp_ge_u32 s53, 16
    s_cbranch_scc1 lwok_41
    s_cmp_lt_u32 s96, 2000000
    s_cbranch_scc1 lw_40
lwok_41:
    ds_read_b128 v[124:127], v45 offset:24576
    ds_read_b128 v[128:131], v45 offset:25600
    ds_read_b128 v[132:135], v45 offset:26624
    ds_read_b128 v[136:139], v45 offset:36864
    ds_read_b128 v[140:143], v45 offset:37888
    ds_read_b128 v[144:147], v45 offset:38912
    s_waitcnt lgkmcnt(3)
    buffer_store_dwordx4 v[124:127], v44, s[24:27], s52 offen offset:0 sc1
    buffer_store_dwordx4 v[128:131], v44, s[24:27], s52 offen offset:1024 sc1
    buffer_store_dwordx4 v[132:135], v44, s[24:27], s52 offen offset:2048 sc1
    s_add_u32 s52, s52, 12288
    s_waitcnt lgkmcnt(0)
    buffer_store_dwordx4 v[136:139], v44, s[24:27], s52 offen offset:0 sc1
    buffer_store_dwordx4 v[140:143], v44, s[24:27], s52 offen offset:1024 sc1
    buffer_store_dwordx4 v[144:147], v44, s[24:27], s52 offen offset:2048 sc1
    s_add_u32 s52, s52, 12288
    s_mov_b32 s96, 0
lw_42:
    ds_read_b128 v[28:31], v33 offset:0
    s_add_u32 s96, s96, 1
    s_waitcnt lgkmcnt(0)
    v_min3_u32 v28, v28, v29, v30
    v_min_u32 v28, v28, v31
    s_nop 0
    v_readfirstlane_b32 s53, v28
    s_nop 0
    s_cmp_ge_u32 s53, 17
    s_cbranch_scc1 lwok_43
    s_cmp_lt_u32 s96, 2000000
    s_cbranch_scc1 lw_42
lwok_43:
    ds_read_b128 v[148:151], v45 offset:49152
    ds_read_b128 v[152:155], v45 offset:50176
    ds_read_b128 v[156:159], v45 offset:51200
    ds_read_b128 v[160:163], v45 offset:61440
    ds_read_b128 v[164:167], v45 offset:62464
    ds_read_b128 v[168:171], v45 offset:63488
    s_waitcnt lgkmcnt(3)
    buffer_store_dwordx4 v[148:151], v44, s[24:27], s52 offen offset:0 sc1
    buffer_store_dwordx4 v[152:155], v44, s[24:27], s52 offen offset:1024 sc1
    buffer_store_dwordx4 v[156:159], v44, s[24:27], s52 offen offset:2048 sc1
    s_add_u32 s52, s52, 12288
    s_waitcnt lgkmcnt(0)
    buffer_store_dwordx4 v[160:163], v44, s[24:27], s52 offen offset:0 sc1
    buffer_store_dwordx4 v[164:167], v44, s[24:27], s52 offen offset:1024 sc1
    buffer_store_dwordx4 v[168:171], v44, s[24:27], s52 offen offset:2048 sc1
    s_add_u32 s52, s52, 12288
    s_barrier
    s_bfe_u32 s63, s101, 0x20002
    s_mul_i32 s63, s63, 6
    s_add_u32 s63, s63, 1
    s_mul_i32 s48, s63, 40960
    s_add_u32 s48, s48, s60
    s_add_u32 s50, s62, 10240
    s_add_u32 m0, s50, 0
    s_nop 0
    buffer_load_dwordx4 v37, s[28:31], s48 offen lds
    s_add_u32 m0, s50, 1024
    s_nop 0
    buffer_load_dwordx4 v38, s[28:31], s48 offen lds
    s_add_u32 m0, s50, 2048
    s_nop 0
    buffer_load_dwordx4 v39, s[28:31], s48 offen lds
    s_add_u32 m0, s50, 3072
    s_nop 0
    buffer_load_dwordx4 v40, s[28:31], s48 offen lds
    s_add_u32 m0, s50, 4096
    s_nop 0
    buffer_load_dwordx4 v41, s[28:31], s48 offen lds
    s_add_u32 s52, s51, 5120
    s_mov_b64 exec, 1
    s_waitcnt vmcnt(5)
    buffer_store_dword v47, v46, s[24:27], s52 offen
    buffer_store_dword v47, v46, s[24:27], s51 offen sc1
    s_mov_b64 exec, -1
    s_barrier
    s_bfe_u32 s63, s101, 0x20002
    s_mul_i32 s63, s63, 6
    s_add_u32 s63, s63, 3
    s_mul_i32 s48, s63, 40960
    s_add_u32 s48, s48, s60
    s_add_u32 s50, s62, 30720
    s_add_u32 m0, s50, 0
    s_nop 0
    buffer_load_dwordx4 v37, s[28:31], s48 offen lds
    s_add_u32 m0, s50, 1024
    s_nop 0
    buffer_load_dwordx4 v38, s[28:31], s48 offen lds
    s_add_u32 m0, s50, 2048
    s_nop 0
    buffer_load_dwordx4 v39, s[28:31], s48 offen lds
    s_add_u32 m0, s50, 3072
    s_nop 0
    buffer_load_dwordx4 v40, s[28:31], s48 offen lds
    s_add_u32 m0, s50, 4096
    s_nop 0
    buffer_load_dwordx4 v41, s[28:31], s48 offen lds
    s_bfe_u32 s63, s101, 0x20002
    s_mul_i32 s63, s63, 6
    s_add_u32 s63, s63, 5
    s_mul_i32 s48, s63, 40960
    s_add_u32 s48, s48, s60
    s_add_u32 s50, s62, 51200
    s_add_u32 m0, s50, 0
    s_nop 0
    buffer_load_dwordx4 v37, s[28:31], s48 offen lds
    s_add_u32 m0, s50, 1024
    s_nop 0
    buffer_load_dwordx4 v38, s[28:31], s48 offen lds
    s_add_u32 m0, s50, 2048
    s_nop 0
    buffer_load_dwordx4 v39, s[28:31], s48 offen lds
    s_add_u32 m0, s50, 3072
    s_nop 0
    buffer_load_dwordx4 v40, s[28:31], s48 offen lds
    s_add_u32 m0, s50, 4096
    s_nop 0
    buffer_load_dwordx4 v41, s[28:31], s48 offen lds
    s_bfe_u32 s51, s101, 0x20002
    s_lshl_b32 s51, s51, 2
    s_lshl_b32 s51, 15, s51
    s_mov_b32 s96, 0
f1poll_44:
    s_and_b32 s48, s96, 7
    s_cmp_eq_u32 s48, 7
    s_cselect_b32 s48, 0, 5120
    buffer_load_dword v52, v42, s[24:27], s48 offen sc1
    s_waitcnt vmcnt(0)
    v_cmp_ne_u32 vcc, 0, v52
    s_add_u32 s96, s96, 1
    s_nop 2
    s_mov_b32 s52, vcc_lo
    s_and_b32 s48, s52, s51
    s_cmp_eq_u32 s48, s51
    s_cbranch_scc1 f1ok_45
    s_cmp_lt_u32 s96, 1000000
    s_cbranch_scc1 f1poll_44
f1ok_45:
    s_bfe_u32 s63, s101, 0x20002
    s_mul_i32 s63, s63, 6
    s_add_u32 s63, s63, 1
    s_mul_i32 s48, s63, 12288
    s_add_u32 s48, s48, s59
    s_add_u32 s49, s48, 4096
    s_add_u32 m0, s61, 12288
    s_nop 0
    buffer_load_dwordx4 v36, s[24:27], s48 offen offset:0 sc1 lds
    buffer_load_dwordx4 v36, s[24:27], s48 offen offset:1024 sc1 lds
    buffer_load_dwordx4 v36, s[24:27], s48 offen offset:2048 sc1 lds
    buffer_load_dwordx4 v36, s[24:27], s48 offen offset:3072 sc1 lds
    s_add_u32 m0, m0, 4096
    s_nop 0
    buffer_load_dwordx4 v36, s[24:27], s49 offen offset:0 sc1 lds
    buffer_load_dwordx4 v36, s[24:27], s49 offen offset:1024 sc1 lds
    s_bfe_u32 s63, s101, 0x20002
    s_mul_i32 s63, s63, 6
    s_add_u32 s63, s63, 3
    s_mul_i32 s48, s63, 12288
    s_add_u32 s48, s48, s59
    s_add_u32 s49, s48, 4096
    s_add_u32 m0, s61, 36864
    s_nop 0
    buffer_load_dwordx4 v36, s[24:27], s48 offen offset:0 sc1 lds
    buffer_load_dwordx4 v36, s[24:27], s48 offen offset:1024 sc1 lds
    buffer_load_dwordx4 v36, s[24:27], s48 offen offset:2048 sc1 lds
    buffer_load_dwordx4 v36, s[24:27], s48 offen offset:3072 sc1 lds
    s_add_u32 m0, m0, 4096
    s_nop 0
    buffer_load_dwordx4 v36, s[24:27], s49 offen offset:0 sc1 lds
    buffer_load_dwordx4 v36, s[24:27], s49 offen offset:1024 sc1 lds
    s_barrier
    s_waitcnt vmcnt(6)
    s_barrier
    s_barrier
    s_bfe_u32 s63, s101, 0x20002
    s_mul_i32 s63, s63, 6
    s_add_u32 s63, s63, 5
    s_mul_i32 s48, s63, 12288
    s_add_u32 s48, s48, s59
    s_add_u32 s49, s48, 4096
    s_add_u32 m0, s61, 61440
    s_nop 0
    buffer_load_dwordx4 v36, s[24:27], s48 offen offset:0 sc1 lds
    buffer_load_dwordx4 v36, s[24:27], s48 offen offset:1024 sc1 lds
    buffer_load_dwordx4 v36, s[24:27], s48 offen offset:2048 sc1 lds
    buffer_load_dwordx4 v36, s[24:27], s48 offen offset:3072 sc1 lds
    s_add_u32 m0, m0, 4096
    s_nop 0
    buffer_load_dwordx4 v36, s[24:27], s49 offen offset:0 sc1 lds
    buffer_load_dwordx4 v36, s[24:27], s49 offen offset:1024 sc1 lds
    s_waitcnt vmcnt(6)
    s_barrier
    s_barrier
    s_bfe_u32 s51, s101, 0x20004
    s_lshl_b32 s51, s51, 2
    s_lshl_b32 s51, 15, s51
    s_and_b32 s48, s52, s51
    s_cmp_eq_u32 s48, s51
    s_cbranch_scc1 f1ok_47
    s_mov_b32 s96, 0
f1poll_46:
    s_and_b32 s48, s96, 7
    s_cmp_eq_u32 s48, 7
    s_cselect_b32 s48, 0, 5120
    buffer_load_dword v52, v42, s[24:27], s48 offen sc1
    s_waitcnt vmcnt(0)
    v_cmp_ne_u32 vcc, 0, v52
    s_add_u32 s96, s96, 1
    s_nop 2
    s_mov_b32 s52, vcc_lo
    s_and_b32 s48, s52, s51
    s_cmp_eq_u32 s48, s51
    s_cbranch_scc1 f1ok_47
    s_cmp_lt_u32 s96, 1000000
    s_cbranch_scc1 f1poll_46
f1ok_47:
    s_bfe_u32 s63, s101, 0x20004
    s_mul_i32 s63, s63, 6
    s_add_u32 s63, s63, 1
    s_mul_i32 s48, s63, 12288
    s_add_u32 s48, s48, s59
    s_add_u32 s49, s48, 4096
    s_add_u32 m0, s61, 12288
    s_nop 0
    buffer_load_dwordx4 v36, s[24:27], s48 offen offset:0 sc1 lds
    buffer_load_dwordx4 v36, s[24:27], s48 offen offset:1024 sc1 lds
    buffer_load_dwordx4 v36, s[24:27], s48 offen offset:2048 sc1 lds
    buffer_load_dwordx4 v36, s[24:27], s48 offen offset:3072 sc1 lds
    s_add_u32 m0, m0, 4096
    s_nop 0
    buffer_load_dwordx4 v36, s[24:27], s49 offen offset:0 sc1 lds
    buffer_load_dwordx4 v36, s[24:27], s49 offen offset:1024 sc1 lds
    s_mul_i32 s48, s63, 40960
    s_add_u32 s48, s48, s60
    s_add_u32 s50, s62, 10240
    s_add_u32 m0, s50, 0
    s_nop 0
    buffer_load_dwordx4 v37, s[28:31], s48 offen lds
    s_add_u32 m0, s50, 1024
    s_nop 0
    buffer_load_dwordx4 v38, s[28:31], s48 offen lds
    s_add_u32 m0, s50, 2048
    s_nop 0
    buffer_load_dwordx4 v39, s[28:31], s48 offen lds
    s_add_u32 m0, s50, 3072
    s_nop 0
    buffer_load_dwordx4 v40, s[28:31], s48 offen lds
    s_add_u32 m0, s50, 4096
    s_nop 0
    buffer_load_dwordx4 v41, s[28:31], s48 offen lds
    s_waitcnt vmcnt(11)
    s_barrier
    s_barrier
    s_bfe_u32 s63, s101, 0x20004
    s_mul_i32 s63, s63, 6
    s_add_u32 s63, s63, 3
    s_mul_i32 s48, s63, 12288
    s_add_u32 s48, s48, s59
    s_add_u32 s49, s48, 4096
    s_add_u32 m0, s61, 36864
    s_nop 0
    buffer_load_dwordx4 v36, s[24:27], s48 offen offset:0 sc1 lds
    buffer_load_dwordx4 v36, s[24:27], s48 offen offset:1024 sc1 lds
    buffer_load_dwordx4 v36, s[24:27], s48 offen offset:2048 sc1 lds
    buffer_load_dwordx4 v36, s[24:27], s48 offen offset:3072 sc1 lds
    s_add_u32 m0, m0, 4096
    s_nop 0
    buffer_load_dwordx4 v36, s[24:27], s49 offen offset:0 sc1 lds
    buffer_load_dwordx4 v36, s[24:27], s49 offen offset:1024 sc1 lds
    s_mul_i32 s48, s63, 40960
    s_add_u32 s48, s48, s60
    s_add_u32 s50, s62, 30720
    s_add_u32 m0, s50, 0
    s_nop 0
    buffer_load_dwordx4 v37, s[28:31], s48 offen lds
    s_add_u32 m0, s50, 1024
    s_nop 0
    buffer_load_dwordx4 v38, s[28:31], s48 offen lds
    s_add_u32 m0, s50, 2048
    s_nop 0
    buffer_load_dwordx4 v39, s[28:31], s48 offen lds
    s_add_u32 m0, s50, 3072
    s_nop 0
    buffer_load_dwordx4 v40, s[28:31], s48 offen lds
    s_add_u32 m0, s50, 4096
    s_nop 0
    buffer_load_dwordx4 v41, s[28:31], s48 offen lds
    s_bfe_u32 s63, s101, 0x20004
    s_mul_i32 s63, s63, 6
    s_add_u32 s63, s63, 5
    s_mul_i32 s48, s63, 12288
    s_add_u32 s48, s48, s59
    s_add_u32 s49, s48, 4096
    s_add_u32 m0, s61, 61440
    s_nop 0
    buffer_load_dwordx4 v36, s[24:27], s48 offen offset:0 sc1 lds
    buffer_load_dwordx4 v36, s[24:27], s48 offen offset:1024 sc1 lds
    buffer_load_dwordx4 v36, s[24:27], s48 offen offset:2048 sc1 lds
    buffer_load_dwordx4 v36, s[24:27], s48 offen offset:3072 sc1 lds
    s_add_u32 m0, m0, 4096
    s_nop 0
    buffer_load_dwordx4 v36, s[24:27], s49 offen offset:0 sc1 lds
    buffer_load_dwordx4 v36, s[24:27], s49 offen offset:1024 sc1 lds
    s_mul_i32 s48, s63, 40960
    s_add_u32 s48, s48, s60
    s_add_u32 s50, s62, 51200
    s_add_u32 m0, s50, 0
    s_nop 0
    buffer_load_dwordx4 v37, s[28:31], s48 offen lds
    s_add_u32 m0, s50, 1024
    s_nop 0
    buffer_load_dwordx4 v38, s[28:31], s48 offen lds
    s_add_u32 m0, s50, 2048
    s_nop 0
    buffer_load_dwordx4 v39, s[28:31], s48 offen lds
    s_add_u32 m0, s50, 3072
    s_nop 0
    buffer_load_dwordx4 v40, s[28:31], s48 offen lds
    s_add_u32 m0, s50, 4096
    s_nop 0
    buffer_load_dwordx4 v41, s[28:31], s48 offen lds
    s_waitcnt vmcnt(22)
    s_barrier
    s_barrier
    s_bfe_u32 s51, s101, 0x20006
    s_lshl_b32 s51, s51, 2
    s_lshl_b32 s51, 15, s51
    s_and_b32 s48, s52, s51
    s_cmp_eq_u32 s48, s51
    s_cbranch_scc1 f1ok_49
    s_mov_b32 s96, 0
f1poll_48:
    s_and_b32 s48, s96, 7
    s_cmp_eq_u32 s48, 7
    s_cselect_b32 s48, 0, 5120
    buffer_load_dword v52, v42, s[24:27], s48 offen sc1
    s_waitcnt vmcnt(0)
    v_cmp_ne_u32 vcc, 0, v52
    s_add_u32 s96, s96, 1
    s_nop 2
    s_mov_b32 s52, vcc_lo
    s_and_b32 s48, s52, s51
    s_cmp_eq_u32 s48, s51
    s_cbranch_scc1 f1ok_49
    s_cmp_lt_u32 s96, 1000000
    s_cbranch_scc1 f1poll_48
f1ok_49:
    s_bfe_u32 s63, s101, 0x20006
    s_mul_i32 s63, s63, 6
    s_add_u32 s63, s63, 1
    s_mul_i32 s48, s63, 12288
    s_add_u32 s48, s48, s59
    s_add_u32 s49, s48, 4096
    s_add_u32 m0, s61, 12288
    s_nop 0
    buffer_load_dwordx4 v36, s[24:27], s48 offen offset:0 sc1 lds
    buffer_load_dwordx4 v36, s[24:27], s48 offen offset:1024 sc1 lds
    buffer_load_dwordx4 v36, s[24:27], s48 offen offset:2048 sc1 lds
    buffer_load_dwordx4 v36, s[24:27], s48 offen offset:3072 sc1 lds
    s_add_u32 m0, m0, 4096
    s_nop 0
    buffer_load_dwordx4 v36, s[24:27], s49 offen offset:0 sc1 lds
    buffer_load_dwordx4 v36, s[24:27], s49 offen offset:1024 sc1 lds
    s_mul_i32 s48, s63, 40960
    s_add_u32 s48, s48, s60
    s_add_u32 s50, s62, 10240
    s_add_u32 m0, s50, 0
    s_nop 0
    buffer_load_dwordx4 v37, s[28:31], s48 offen lds
    s_add_u32 m0, s50, 1024
    s_nop 0
    buffer_load_dwordx4 v38, s[28:31], s48 offen lds
    s_add_u32 m0, s50, 2048
    s_nop 0
    buffer_load_dwordx4 v39, s[28:31], s48 offen lds
    s_add_u32 m0, s50, 3072
    s_nop 0
    buffer_load_dwordx4 v40, s[28:31], s48 offen lds
    s_add_u32 m0, s50, 4096
    s_nop 0
    buffer_load_dwordx4 v41, s[28:31], s48 offen lds
    s_waitcnt vmcnt(22)
    s_barrier
    s_barrier
    s_bfe_u32 s63, s101, 0x20006
    s_mul_i32 s63, s63, 6
    s_add_u32 s63, s63, 3
    s_mul_i32 s48, s63, 12288
    s_add_u32 s48, s48, s59
    s_add_u32 s49, s48, 4096
    s_add_u32 m0, s61, 36864
    s_nop 0
    buffer_load_dwordx4 v36, s[24:27], s48 offen offset:0 sc1 lds
    buffer_load_dwordx4 v36, s[24:27], s48 offen offset:1024 sc1 lds
    buffer_load_dwordx4 v36, s[24:27], s48 offen offset:2048 sc1 lds
    buffer_load_dwordx4 v36, s[24:27], s48 offen offset:3072 sc1 lds
    s_add_u32 m0, m0, 4096
    s_nop 0
    buffer_load_dwordx4 v36, s[24:27], s49 offen offset:0 sc1 lds
    buffer_load_dwordx4 v36, s[24:27], s49 offen offset:1024 sc1 lds
    s_mul_i32 s48, s63, 40960
    s_add_u32 s48, s48, s60
    s_add_u32 s50, s62, 30720
    s_add_u32 m0, s50, 0
    s_nop 0
    buffer_load_dwordx4 v37, s[28:31], s48 offen lds
    s_add_u32 m0, s50, 1024
    s_nop 0
    buffer_load_dwordx4 v38, s[28:31], s48 offen lds
    s_add_u32 m0, s50, 2048
    s_nop 0
    buffer_load_dwordx4 v39, s[28:31], s48 offen lds
    s_add_u32 m0, s50, 3072
    s_nop 0
    buffer_load_dwordx4 v40, s[28:31], s48 offen lds
    s_add_u32 m0, s50, 4096
    s_nop 0
    buffer_load_dwordx4 v41, s[28:31], s48 offen lds
    s_waitcnt vmcnt(22)
    s_barrier
    s_barrier
    s_bfe_u32 s63, s101, 0x20006
    s_mul_i32 s63, s63, 6
    s_add_u32 s63, s63, 5
    s_mul_i32 s48, s63, 12288
    s_add_u32 s48, s48, s59
    s_add_u32 s49, s48, 4096
    s_add_u32 m0, s61, 61440
    s_nop 0
    buffer_load_dwordx4 v36, s[24:27], s48 offen offset:0 sc1 lds
    buffer_load_dwordx4 v36, s[24:27], s48 offen offset:1024 sc1 lds
    buffer_load_dwordx4 v36, s[24:27], s48 offen offset:2048 sc1 lds
    buffer_load_dwordx4 v36, s[24:27], s48 offen offset:3072 sc1 lds
    s_add_u32 m0, m0, 4096
    s_nop 0
    buffer_load_dwordx4 v36, s[24:27], s49 offen offset:0 sc1 lds
    buffer_load_dwordx4 v36, s[24:27], s49 offen offset:1024 sc1 lds
    s_mul_i32 s48, s63, 40960
    s_add_u32 s48, s48, s60
    s_add_u32 s50, s62, 51200
    s_add_u32 m0, s50, 0
    s_nop 0
    buffer_load_dwordx4 v37, s[28:31], s48 offen lds
    s_add_u32 m0, s50, 1024
    s_nop 0
    buffer_load_dwordx4 v38, s[28:31], s48 offen lds
    s_add_u32 m0, s50, 2048
    s_nop 0
    buffer_load_dwordx4 v39, s[28:31], s48 offen lds
    s_add_u32 m0, s50, 3072
    s_nop 0
    buffer_load_dwordx4 v40, s[28:31], s48 offen lds
    s_add_u32 m0, s50, 4096
    s_nop 0
    buffer_load_dwordx4 v41, s[28:31], s48 offen lds
    s_waitcnt vmcnt(22)
    s_barrier
    s_barrier
    s_waitcnt vmcnt(11)
    s_barrier
    s_barrier
    s_waitcnt vmcnt(0)
    s_barrier
    s_barrier
ldone_5:
    s_endpgm
kcomp_2:
    s_waitcnt lgkmcnt(0)
    s_mov_b32 s8, s70
    s_and_b32 s9, s71, 0xffff
    s_mov_b32 s10, 7864320
    s_mov_b32 s11, 0x20000
    s_mov_b32 s12, s64
    s_and_b32 s13, s65, 0xffff
    s_mov_b32 s14, 983040
    s_mov_b32 s15, 0x20000
    s_mov_b32 s24, s74
    s_and_b32 s25, s75, 0xffff
    s_mov_b32 s26, 268435456
    s_mov_b32 s27, 0x20000
    s_mov_b32 s16, s66
    s_and_b32 s17, s67, 0xffff
    s_mov_b32 s18, 9437184
    s_mov_b32 s19, 0x20000
    s_mov_b32 s20, s68
    s_and_b32 s21, s69, 0xffff
    s_mov_b32 s22, 9437184
    s_mov_b32 s23, 0x20000
    s_mov_b32 s28, s72
    s_and_b32 s29, s73, 0xffff
    s_mov_b32 s30, 7864320
    s_mov_b32 s31, 0x20000
    s_mov_b32 s32, s76
    s_and_b32 s33, s77, 0xffff
    s_mov_b32 s34, 1966080
    s_mov_b32 s35, 0x20000
    s_mov_b32 s4, s78
    s_and_b32 s5, s79, 0xffff
    s_mov_b32 s6, 256
    s_mov_b32 s7, 0x20000
    s_lshl_b32 s48, s38, 2
    s_add_u32 s48, s48, s41
    s_lshl_b32 s48, s48, 13
    s_add_u32 s54, s48, 41943040
    s_lshr_b32 s48, s42, 2
    s_lshl_b32 s55, s39, 1
    s_add_u32 s55, s55, s48
    s_lshl_b32 s48, s43, 2
    s_add_u32 s48, s48, 163344
    v_lshlrev_b32 v34, 2, v0
    v_add_u32 v34, 163584, v34
    v_cmp_eq_u32 vcc, 0, v0
    v_mov_b32 v32, s48
    v_mov_b32 v33, 163328
    v_cndmask_b32 v32, v34, v32, vcc
    v_mov_b32 v34, 0
    ds_write_b32 v32, v34
    s_waitcnt lgkmcnt(0)
    s_or_b32 s48, s39, s42
    s_or_b32 s48, s48, s3
    s_cmp_lg_u32 s48, 0
    s_cbranch_scc1 clr_50
    v_lshlrev_b32 v16, 4, v0
    v_mov_b32 v20, 0
    v_mov_b32 v21, 0
    v_mov_b32 v22, 0
    v_mov_b32 v23, 0
    s_add_u32 s48, s54, 4096
    buffer_store_dwordx4 v[20:23], v16, s[24:27], s54 offen offset:0 sc1
    buffer_store_dwordx4 v[20:23], v16, s[24:27], s54 offen offset:1024 sc1
    buffer_store_dwordx4 v[20:23], v16, s[24:27], s54 offen offset:2048 sc1
    buffer_store_dwordx4 v[20:23], v16, s[24:27], s54 offen offset:3072 sc1
    buffer_store_dwordx4 v[20:23], v16, s[24:27], s48 offen offset:0 sc1
    buffer_store_dwordx4 v[20:23], v16, s[24:27], s48 offen offset:1024 sc1
    s_lshl_b32 s48, s38, 2
    s_add_u32 s48, s48, s41
    s_lshl_b32 s48, s48, 2
    v_mov_b32 v17, 0
    v_mov_b32 v18, 1
    s_mov_b64 exec, 1
    s_waitcnt vmcnt(0)
    buffer_store_dword v18, v17, s[4:7], s48 offen sc1
    s_mov_b64 exec, -1
clr_50:
    v_and_b32 v12, 15, v0
    v_lshrrev_b32 v13, 4, v0
    v_bfe_u32 v14, v0, 2, 2
    v_and_b32 v15, 3, v0
    v_lshl_add_u32 v16, v13, 3, v14
    v_lshlrev_b32 v16, 7, v16
    v_lshl_add_u32 v16, v15, 3, v16
    v_lshrrev_b32 v17, 1, v14
    v_and_b32 v18, 1, v13
    v_lshl_or_b32 v17, v18, 1, v17
    v_xor_b32 v18, 0, v17
    v_lshl_add_u32 v2, v18, 5, v16
    v_xor_b32 v18, 1, v17
    v_lshl_add_u32 v3, v18, 5, v16
    v_xor_b32 v18, 2, v17
    v_lshl_add_u32 v4, v18, 5, v16
    v_xor_b32 v18, 3, v17
    v_lshl_add_u32 v5, v18, 5, v16
    s_mul_i32 s48, s3, 6144
    s_add_u32 s50, s48, 24576
    v_lshrrev_b32 v17, 1, v12
    v_xor_b32 v19, v17, v13
    v_lshlrev_b32 v19, 4, v19
    v_lshl_add_u32 v19, v12, 7, v19
    v_add_u32 v6, s50, v19
    v_xor_b32 v7, 64, v6
    s_mul_i32 s49, s3, 18432
    s_add_u32 s49, s49, 89600
    v_lshrrev_b32 v18, 1, v13
    v_xor_b32 v18, v18, v17
    v_lshlrev_b32 v18, 4, v18
    v_lshl_add_u32 v18, v12, 7, v18
    v_and_b32 v19, 1, v13
    v_lshl_add_u32 v18, v19, 3, v18
    v_xor_b32 v19, 0, v18
    v_add_u32 v20, s49, v19
    v_xor_b32 v19, 32, v18
    v_add_u32 v21, s49, v19
    v_xor_b32 v19, 64, v18
    v_add_u32 v22, s49, v19
    v_xor_b32 v19, 96, v18
    v_add_u32 v23, s49, v19
    v_lshl_add_u32 v17, v13, 2, v14
    v_bfe_u32 v18, v17, 1, 2
    v_lshlrev_b32 v17, 7, v17
    v_lshl_add_u32 v17, v15, 3, v17
    v_add_u32 v17, s48, v17
    v_xor_b32 v19, 0, v18
    v_lshl_add_u32 v24, v19, 5, v17
    v_xor_b32 v19, 1, v18
    v_lshl_add_u32 v25, v19, 5, v17
    v_xor_b32 v19, 2, v18
    v_lshl_add_u32 v26, v19, 5, v17
    v_xor_b32 v19, 3, v18
    v_lshl_add_u32 v27, v19, 5, v17
    v_lshlrev_b32 v10, 4, v0
    s_mul_i32 s48, s3, 3072
    v_add_u32 v8, s48, v10
    v_mov_b32 v64, 0
    v_mov_b32 v65, 0
    v_mov_b32 v66, 0
    v_mov_b32 v67, 0
    v_mov_b32 v68, 0
    v_mov_b32 v69, 0
    v_mov_b32 v70, 0
    v_mov_b32 v71, 0
    v_mov_b32 v72, 0
    v_mov_b32 v73, 0
    v_mov_b32 v74, 0
    v_mov_b32 v75, 0
    v_mov_b32 v76, 0
    v_mov_b32 v77, 0
    v_mov_b32 v78, 0
    v_mov_b32 v79, 0
    v_mov_b32 v80, 0
    v_mov_b32 v81, 0
    v_mov_b32 v82, 0
    v_mov_b32 v83, 0
    v_mov_b32 v84, 0
    v_mov_b32 v85, 0
    v_mov_b32 v86, 0
    v_mov_b32 v87, 0
    v_mov_b32 v88, 0
    v_mov_b32 v89, 0
    v_mov_b32 v90, 0
    v_mov_b32 v91, 0
    v_mov_b32 v92, 0
    v_mov_b32 v93, 0
    v_mov_b32 v94, 0
    v_mov_b32 v95, 0
    v_mov_b32 v96, 0
    v_mov_b32 v97, 0
    v_mov_b32 v98, 0
    v_mov_b32 v99, 0
    v_mov_b32 v100, 0
    v_mov_b32 v101, 0
    v_mov_b32 v102, 0
    v_mov_b32 v103, 0
    v_mov_b32 v104, 0
    v_mov_b32 v105, 0
    v_mov_b32 v106, 0
    v_mov_b32 v107, 0
    v_mov_b32 v108, 0
    v_mov_b32 v109, 0
    v_mov_b32 v110, 0
    v_mov_b32 v111, 0
    v_mov_b32 v112, 0
    v_mov_b32 v113, 0
    v_mov_b32 v114, 0
    v_mov_b32 v115, 0
    v_mov_b32 v116, 0
    v_mov_b32 v117, 0
    v_mov_b32 v118, 0
    v_mov_b32 v119, 0
    v_mov_b32 v120, 0
    v_mov_b32 v121, 0
    v_mov_b32 v122, 0
    v_mov_b32 v123, 0
    v_mov_b32 v124, 0
    v_mov_b32 v125, 0
    v_mov_b32 v126, 0
    v_mov_b32 v127, 0
    v_mov_b32 v128, 0
    v_mov_b32 v129, 0
    v_mov_b32 v130, 0
    v_mov_b32 v131, 0
    v_mov_b32 v132, 0
    v_mov_b32 v133, 0
    v_mov_b32 v134, 0
    v_mov_b32 v135, 0
    v_mov_b32 v136, 0
    v_mov_b32 v137, 0
    v_mov_b32 v138, 0
    v_mov_b32 v139, 0
    v_mov_b32 v140, 0
    v_mov_b32 v141, 0
    v_mov_b32 v142, 0
    v_mov_b32 v143, 0
    v_mov_b32 v144, 0
    v_mov_b32 v145, 0
    v_mov_b32 v146, 0
    v_mov_b32 v147, 0
    v_mov_b32 v148, 0
    v_mov_b32 v149, 0
    v_mov_b32 v150, 0
    v_mov_b32 v151, 0
    v_mov_b32 v152, 0
    v_mov_b32 v153, 0
    v_mov_b32 v154, 0
    v_mov_b32 v155, 0
    v_mov_b32 v156, 0
    v_mov_b32 v157, 0
    v_mov_b32 v158, 0
    v_mov_b32 v159, 0
    v_mov_b32 v160, 0
    v_mov_b32 v161, 0
    v_mov_b32 v162, 0
    v_mov_b32 v163, 0
    v_mov_b32 v164, 0
    v_mov_b32 v165, 0
    v_mov_b32 v166, 0
    v_mov_b32 v167, 0
    v_mov_b32 v168, 0
    v_mov_b32 v169, 0
    v_mov_b32 v170, 0
    v_mov_b32 v171, 0
    v_mov_b32 v172, 0
    v_mov_b32 v173, 0
    v_mov_b32 v174, 0
    v_mov_b32 v175, 0
    v_mov_b32 v176, 0
    v_mov_b32 v177, 0
    v_mov_b32 v178, 0
    v_mov_b32 v179, 0
    v_mov_b32 v180, 0
    v_mov_b32 v181, 0
    v_mov_b32 v182, 0
    v_mov_b32 v183, 0
    v_mov_b32 v184, 0
    v_mov_b32 v185, 0
    v_mov_b32 v186, 0
    v_mov_b32 v187, 0
    v_mov_b32 v188, 0
    v_mov_b32 v189, 0
    v_mov_b32 v190, 0
    v_mov_b32 v191, 0
    v_mov_b32 v192, 0
    v_mov_b32 v193, 0
    v_mov_b32 v194, 0
    v_mov_b32 v195, 0
    v_mov_b32 v196, 0
    v_mov_b32 v197, 0
    v_mov_b32 v198, 0
    v_mov_b32 v199, 0
    v_mov_b32 v200, 0
    v_mov_b32 v201, 0
    v_mov_b32 v202, 0
    v_mov_b32 v203, 0
    v_mov_b32 v204, 0
    v_mov_b32 v205, 0
    v_mov_b32 v206, 0
    v_mov_b32 v207, 0
    v_mov_b32 v208, 0
    v_mov_b32 v209, 0
    v_mov_b32 v210, 0
    v_mov_b32 v211, 0
    v_mov_b32 v212, 0
    v_mov_b32 v213, 0
    v_mov_b32 v214, 0
    v_mov_b32 v215, 0
    v_mov_b32 v216, 0
    v_mov_b32 v217, 0
    v_mov_b32 v218, 0
    v_mov_b32 v219, 0
    v_mov_b32 v220, 0
    v_mov_b32 v221, 0
    v_mov_b32 v222, 0
    v_mov_b32 v223, 0
    v_mov_b32 v224, 0
    v_mov_b32 v225, 0
    v_mov_b32 v226, 0
    v_mov_b32 v227, 0
    v_mov_b32 v228, 0
    v_mov_b32 v229, 0
    v_mov_b32 v230, 0
    v_mov_b32 v231, 0
    v_mov_b32 v232, 0
    v_mov_b32 v233, 0
    v_mov_b32 v234, 0
    v_mov_b32 v235, 0
    v_mov_b32 v236, 0
    v_mov_b32 v237, 0
    v_mov_b32 v238, 0
    v_mov_b32 v239, 0
    v_mov_b32 v240, 0
    v_mov_b32 v241, 0
    v_mov_b32 v242, 0
    v_mov_b32 v243, 0
    v_mov_b32 v244, 0
    v_mov_b32 v245, 0
    v_mov_b32 v246, 0
    v_mov_b32 v247, 0
    v_mov_b32 v248, 0
    v_mov_b32 v249, 0
    v_mov_b32 v250, 0
    v_mov_b32 v251, 0
    v_mov_b32 v252, 0
    v_mov_b32 v253, 0
    v_mov_b32 v254, 0
    v_mov_b32 v255, 0
    s_mov_b32 s56, 0
    s_mov_b32 s57, 1
    s_mov_b32 s98, 0
    s_barrier
    s_barrier
p1loop_51:
    v_mfma_f32_16x16x32_bf16 v[220:223], v[76:79], v[100:103], v[220:223]
    ds_read_b128 v[88:91], v6 offset:0
    ds_read_b64_tr_b16 v[64:65], v2 offset:0
    v_mfma_f32_16x16x32_bf16 v[224:227], v[76:79], v[104:107], v[224:227]
    ds_read_b64_tr_b16 v[66:67], v2 offset:512
    ds_read_b128 v[92:95], v6 offset:2048
    v_mfma_f32_16x16x32_bf16 v[228:231], v[76:79], v[108:111], v[228:231]
    ds_read_b64_tr_b16 v[68:69], v3 offset:0
    ds_read_b64_tr_b16 v[70:71], v3 offset:512
    v_mfma_f32_16x16x32_bf16 v[232:235], v[80:83], v[100:103], v[232:235]
    ds_read_b128 v[96:99], v6 offset:4096
    ds_read_b64_tr_b16 v[72:73], v4 offset:0
    v_mfma_f32_16x16x32_bf16 v[236:239], v[80:83], v[104:107], v[236:239]
    ds_read_b64_tr_b16 v[74:75], v4 offset:512
    ds_read_b64_tr_b16 v[76:77], v5 offset:0
    v_mfma_f32_16x16x32_bf16 v[240:243], v[80:83], v[108:111], v[240:243]
    ds_read_b64_tr_b16 v[78:79], v5 offset:512
    v_mfma_f32_16x16x32_bf16 v[244:247], v[84:87], v[100:103], v[244:247]
    ds_read_b64_tr_b16 v[80:81], v2 offset:8192
    v_mfma_f32_16x16x32_bf16 v[248:251], v[84:87], v[104:107], v[248:251]
    ds_read_b64_tr_b16 v[82:83], v2 offset:8704
    v_mfma_f32_16x16x32_bf16 v[252:255], v[84:87], v[108:111], v[252:255]
    s_waitcnt lgkmcnt(10)
    v_mfma_f32_16x16x32_bf16 v[112:115], v[64:67], v[88:91], v[112:115]
    ds_read_b64_tr_b16 v[84:85], v3 offset:8192
    s_cmp_eq_u32 s56, 0
    s_waitcnt lgkmcnt(10)
    v_mfma_f32_16x16x32_bf16 v[116:119], v[64:67], v[92:95], v[116:119]
    ds_read_b64_tr_b16 v[86:87], v3 offset:8704
    s_mov_b32 s58, 4294918144
    s_waitcnt lgkmcnt(8)
    v_mfma_f32_16x16x32_bf16 v[120:123], v[64:67], v[96:99], v[120:123]
    s_cmov_b32 s58, 98304
    v_mfma_f32_16x16x32_bf16 v[124:127], v[68:71], v[88:91], v[124:127]
    ds_read_b64_tr_b16 v[64:65], v4 offset:8192
    s_add_u32 s56, s56, s58
    v_mfma_f32_16x16x32_bf16 v[128:131], v[68:71], v[92:95], v[128:131]
    ds_read_b64_tr_b16 v[66:67], v4 offset:8704
    v_add_u32 v6, s58, v6
    v_mfma_f32_16x16x32_bf16 v[132:135], v[68:71], v[96:99], v[132:135]
    s_add_u32 s57, s57, 1
    s_waitcnt lgkmcnt(8)
    v_mfma_f32_16x16x32_bf16 v[136:139], v[72:75], v[88:91], v[136:139]
    ds_read_b64_tr_b16 v[68:69], v5 offset:8192
    v_mfma_f32_16x16x32_bf16 v[140:143], v[72:75], v[92:95], v[140:143]
    ds_read_b64_tr_b16 v[70:71], v5 offset:8704
    v_mfma_f32_16x16x32_bf16 v[144:147], v[72:75], v[96:99], v[144:147]
    s_waitcnt lgkmcnt(8)
    v_mfma_f32_16x16x32_bf16 v[148:151], v[76:79], v[88:91], v[148:151]
    ds_read_b64_tr_b16 v[72:73], v2 offset:16384
    v_mfma_f32_16x16x32_bf16 v[152:155], v[76:79], v[92:95], v[152:155]
    ds_read_b64_tr_b16 v[74:75], v2 offset:16896
    v_mfma_f32_16x16x32_bf16 v[156:159], v[76:79], v[96:99], v[156:159]
    ds_read_b128 v[100:103], v7 offset:0
    s_waitcnt lgkmcnt(9)
    v_mfma_f32_16x16x32_bf16 v[160:163], v[80:83], v[88:91], v[160:163]
    ds_read_b64_tr_b16 v[76:77], v3 offset:16384
    v_mfma_f32_16x16x32_bf16 v[164:167], v[80:83], v[92:95], v[164:167]
    ds_read_b64_tr_b16 v[78:79], v3 offset:16896
    v_mfma_f32_16x16x32_bf16 v[168:171], v[80:83], v[96:99], v[168:171]
    ds_read_b128 v[104:107], v7 offset:2048
    s_waitcnt lgkmcnt(10)
    v_mfma_f32_16x16x32_bf16 v[172:175], v[84:87], v[88:91], v[172:175]
    ds_read_b64_tr_b16 v[80:81], v4 offset:16384
    v_mfma_f32_16x16x32_bf16 v[176:179], v[84:87], v[92:95], v[176:179]
    ds_read_b64_tr_b16 v[82:83], v4 offset:16896
    v_mfma_f32_16x16x32_bf16 v[180:183], v[84:87], v[96:99], v[180:183]
    ds_read_b128 v[108:111], v7 offset:4096
    s_waitcnt lgkmcnt(11)
    v_mfma_f32_16x16x32_bf16 v[184:187], v[64:67], v[88:91], v[184:187]
    ds_read_b64_tr_b16 v[84:85], v5 offset:16384
    v_add_u32 v7, s58, v7
    v_mfma_f32_16x16x32_bf16 v[188:191], v[64:67], v[92:95], v[188:191]
    ds_read_b64_tr_b16 v[86:87], v5 offset:16896
    v_mfma_f32_16x16x32_bf16 v[192:195], v[64:67], v[96:99], v[192:195]
    s_waitcnt lgkmcnt(11)
    v_mfma_f32_16x16x32_bf16 v[196:199], v[68:71], v[88:91], v[196:199]
    ds_read_b64_tr_b16 v[64:65], v2 offset:4096
    v_mfma_f32_16x16x32_bf16 v[200:203], v[68:71], v[92:95], v[200:203]
    ds_read_b64_tr_b16 v[66:67], v2 offset:4608
    v_mfma_f32_16x16x32_bf16 v[204:207], v[68:71], v[96:99], v[204:207]
    s_waitcnt lgkmcnt(11)
    v_mfma_f32_16x16x32_bf16 v[208:211], v[72:75], v[88:91], v[208:211]
    ds_read_b64_tr_b16 v[68:69], v3 offset:4096
    v_mfma_f32_16x16x32_bf16 v[212:215], v[72:75], v[92:95], v[212:215]
    ds_read_b64_tr_b16 v[70:71], v3 offset:4608
    v_mfma_f32_16x16x32_bf16 v[216:219], v[72:75], v[96:99], v[216:219]
    s_waitcnt lgkmcnt(10)
    v_mfma_f32_16x16x32_bf16 v[220:223], v[76:79], v[88:91], v[220:223]
    ds_read_b64_tr_b16 v[72:73], v4 offset:4096
    v_mfma_f32_16x16x32_bf16 v[224:227], v[76:79], v[92:95], v[224:227]
    ds_read_b64_tr_b16 v[74:75], v4 offset:4608
    v_mfma_f32_16x16x32_bf16 v[228:231], v[76:79], v[96:99], v[228:231]
    s_waitcnt lgkmcnt(9)
    v_mfma_f32_16x16x32_bf16 v[232:235], v[80:83], v[88:91], v[232:235]
    ds_read_b64_tr_b16 v[76:77], v5 offset:4096
    v_mfma_f32_16x16x32_bf16 v[236:239], v[80:83], v[92:95], v[236:239]
    ds_read_b64_tr_b16 v[78:79], v5 offset:4608
    v_mfma_f32_16x16x32_bf16 v[240:243], v[80:83], v[96:99], v[240:243]
    s_waitcnt lgkmcnt(8)
    v_mfma_f32_16x16x32_bf16 v[244:247], v[84:87], v[88:91], v[244:247]
    ds_read_b64_tr_b16 v[80:81], v2 offset:12288
    v_mfma_f32_16x16x32_bf16 v[248:251], v[84:87], v[92:95], v[248:251]
    ds_read_b64_tr_b16 v[82:83], v2 offset:12800
    v_mfma_f32_16x16x32_bf16 v[252:255], v[84:87], v[96:99], v[252:255]
    s_waitcnt lgkmcnt(8)
    v_mfma_f32_16x16x32_bf16 v[112:115], v[64:67], v[100:103], v[112:115]
    ds_read_b64_tr_b16 v[84:85], v3 offset:12288
    v_mfma_f32_16x16x32_bf16 v[116:119], v[64:67], v[104:107], v[116:119]
    ds_read_b64_tr_b16 v[86:87], v3 offset:12800
    v_mfma_f32_16x16x32_bf16 v[120:123], v[64:67], v[108:111], v[120:123]
    s_waitcnt lgkmcnt(8)
    v_mfma_f32_16x16x32_bf16 v[124:127], v[68:71], v[100:103], v[124:127]
    ds_read_b64_tr_b16 v[64:65], v4 offset:12288
    v_mfma_f32_16x16x32_bf16 v[128:131], v[68:71], v[104:107], v[128:131]
    ds_read_b64_tr_b16 v[66:67], v4 offset:12800
    v_mfma_f32_16x16x32_bf16 v[132:135], v[68:71], v[108:111], v[132:135]
    s_waitcnt lgkmcnt(8)
    v_mfma_f32_16x16x32_bf16 v[136:139], v[72:75], v[100:103], v[136:139]
    ds_read_b64_tr_b16 v[68:69], v5 offset:12288
    v_mfma_f32_16x16x32_bf16 v[140:143], v[72:75], v[104:107], v[140:143]
    ds_read_b64_tr_b16 v[70:71], v5 offset:12800
    v_mfma_f32_16x16x32_bf16 v[144:147], v[72:75], v[108:111], v[144:147]
    s_waitcnt lgkmcnt(8)
    v_mfma_f32_16x16x32_bf16 v[148:151], v[76:79], v[100:103], v[148:151]
    ds_read_b64_tr_b16 v[72:73], v2 offset:20480
    v_mfma_f32_16x16x32_bf16 v[152:155], v[76:79], v[104:107], v[152:155]
    ds_read_b64_tr_b16 v[74:75], v2 offset:20992
    v_mfma_f32_16x16x32_bf16 v[156:159], v[76:79], v[108:111], v[156:159]
    s_waitcnt lgkmcnt(8)
    v_mfma_f32_16x16x32_bf16 v[160:163], v[80:83], v[100:103], v[160:163]
    ds_read_b64_tr_b16 v[76:77], v3 offset:20480
    v_mfma_f32_16x16x32_bf16 v[164:167], v[80:83], v[104:107], v[164:167]
    ds_read_b64_tr_b16 v[78:79], v3 offset:20992
    v_mfma_f32_16x16x32_bf16 v[168:171], v[80:83], v[108:111], v[168:171]
    s_waitcnt lgkmcnt(8)
    v_mfma_f32_16x16x32_bf16 v[172:175], v[84:87], v[100:103], v[172:175]
    ds_read_b64_tr_b16 v[80:81], v4 offset:20480
    v_add_u32 v2, s58, v2
    v_mfma_f32_16x16x32_bf16 v[176:179], v[84:87], v[104:107], v[176:179]
    ds_read_b64_tr_b16 v[82:83], v4 offset:20992
    v_mfma_f32_16x16x32_bf16 v[180:183], v[84:87], v[108:111], v[180:183]
    s_waitcnt lgkmcnt(8)
    v_mfma_f32_16x16x32_bf16 v[184:187], v[64:67], v[100:103], v[184:187]
    ds_read_b64_tr_b16 v[84:85], v5 offset:20480
    v_mfma_f32_16x16x32_bf16 v[188:191], v[64:67], v[104:107], v[188:191]
    ds_read_b64_tr_b16 v[86:87], v5 offset:20992
    v_mfma_f32_16x16x32_bf16 v[192:195], v[64:67], v[108:111], v[192:195]
    s_waitcnt lgkmcnt(8)
    v_mfma_f32_16x16x32_bf16 v[196:199], v[68:71], v[100:103], v[196:199]
    v_add_u32 v3, s58, v3
    v_mfma_f32_16x16x32_bf16 v[200:203], v[68:71], v[104:107], v[200:203]
    v_add_u32 v4, s58, v4
    v_mfma_f32_16x16x32_bf16 v[204:207], v[68:71], v[108:111], v[204:207]
    v_add_u32 v5, s58, v5
    s_waitcnt lgkmcnt(6)
    v_mfma_f32_16x16x32_bf16 v[208:211], v[72:75], v[100:103], v[208:211]
    s_cmp_le_u32 s57, 10
    v_mfma_f32_16x16x32_bf16 v[212:215], v[72:75], v[104:107], v[212:215]
    v_mfma_f32_16x16x32_bf16 v[216:219], v[72:75], v[108:111], v[216:219]
    s_waitcnt lgkmcnt(0)
    s_barrier
    s_cbranch_scc1 p1loop_51
    v_mfma_f32_16x16x32_bf16 v[220:223], v[76:79], v[100:103], v[220:223]
    v_cvt_pk_bf16_f32 v112, v112, v113
    v_cvt_pk_bf16_f32 v113, v114, v115
    v_cvt_pk_bf16_f32 v114, v124, v125
    v_mfma_f32_16x16x32_bf16 v[224:227], v[76:79], v[104:107], v[224:227]
    v_cvt_pk_bf16_f32 v115, v126, v127
    ds_read_b64 v[124:125], v20 offset:0
    ds_read_b64 v[126:127], v21 offset:0
    v_mfma_f32_16x16x32_bf16 v[228:231], v[76:79], v[108:111], v[228:231]
    v_cvt_pk_bf16_f32 v116, v116, v117
    v_cvt_pk_bf16_f32 v117, v118, v119
    v_cvt_pk_bf16_f32 v118, v128, v129
    v_mfma_f32_16x16x32_bf16 v[232:235], v[80:83], v[100:103], v[232:235]
    v_cvt_pk_bf16_f32 v119, v130, v131
    ds_read_b64 v[128:129], v20 offset:2048
    ds_read_b64 v[130:131], v21 offset:2048
    v_mfma_f32_16x16x32_bf16 v[236:239], v[80:83], v[104:107], v[236:239]
    v_cvt_pk_bf16_f32 v120, v120, v121
    v_cvt_pk_bf16_f32 v121, v122, v123
    v_cvt_pk_bf16_f32 v122, v132, v133
    v_mfma_f32_16x16x32_bf16 v[240:243], v[80:83], v[108:111], v[240:243]
    v_cvt_pk_bf16_f32 v123, v134, v135
    ds_read_b64 v[132:133], v20 offset:4096
    ds_read_b64 v[134:135], v21 offset:4096
    v_mfma_f32_16x16x32_bf16 v[244:247], v[84:87], v[100:103], v[244:247]
    v_cvt_pk_bf16_f32 v136, v136, v137
    v_cvt_pk_bf16_f32 v137, v138, v139
    v_cvt_pk_bf16_f32 v138, v148, v149
    v_mfma_f32_16x16x32_bf16 v[248:251], v[84:87], v[104:107], v[248:251]
    v_cvt_pk_bf16_f32 v139, v150, v151
    ds_read_b64 v[148:149], v22 offset:0
    ds_read_b64 v[150:151], v23 offset:0
    v_mfma_f32_16x16x32_bf16 v[252:255], v[84:87], v[108:111], v[252:255]
    v_cvt_pk_bf16_f32 v140, v140, v141
    v_cvt_pk_bf16_f32 v141, v142, v143
    v_cvt_pk_bf16_f32 v142, v152, v153
    v_cvt_pk_bf16_f32 v143, v154, v155
    ds_read_b64 v[152:153], v22 offset:2048
    ds_read_b64 v[154:155], v23 offset:2048
    v_cvt_pk_bf16_f32 v144, v144, v145
    v_cvt_pk_bf16_f32 v145, v146, v147
    v_cvt_pk_bf16_f32 v146, v156, v157
    v_cvt_pk_bf16_f32 v147, v158, v159
    ds_read_b64 v[156:157], v22 offset:4096
    ds_read_b64 v[158:159], v23 offset:4096
    s_waitcnt lgkmcnt(10)
    v_mfma_f32_16x16x32_bf16 v[64:67], v[124:127], v[112:115], 0
    v_cvt_pk_bf16_f32 v160, v160, v161
    v_cvt_pk_bf16_f32 v161, v162, v163
    v_mfma_f32_16x16x32_bf16 v[76:79], v[124:127], v[116:119], 0
    v_cvt_pk_bf16_f32 v162, v172, v173
    v_cvt_pk_bf16_f32 v163, v174, v175
    v_mfma_f32_16x16x32_bf16 v[88:91], v[124:127], v[120:123], 0
    ds_read_b64 v[172:173], v20 offset:6144
    ds_read_b64 v[174:175], v21 offset:6144
    s_waitcnt lgkmcnt(10)
    v_mfma_f32_16x16x32_bf16 v[68:71], v[128:131], v[112:115], 0
    v_cvt_pk_bf16_f32 v164, v164, v165
    v_cvt_pk_bf16_f32 v165, v166, v167
    v_mfma_f32_16x16x32_bf16 v[80:83], v[128:131], v[116:119], 0
    v_cvt_pk_bf16_f32 v166, v176, v177
    v_cvt_pk_bf16_f32 v167, v178, v179
    v_mfma_f32_16x16x32_bf16 v[92:95], v[128:131], v[120:123], 0
    ds_read_b64 v[176:177], v20 offset:8192
    ds_read_b64 v[178:179], v21 offset:8192
    s_waitcnt lgkmcnt(10)
    v_mfma_f32_16x16x32_bf16 v[72:75], v[132:135], v[112:115], 0
    v_cvt_pk_bf16_f32 v168, v168, v169
    v_cvt_pk_bf16_f32 v169, v170, v171
    v_mfma_f32_16x16x32_bf16 v[84:87], v[132:135], v[116:119], 0
    v_cvt_pk_bf16_f32 v170, v180, v181
    v_cvt_pk_bf16_f32 v171, v182, v183
    v_mfma_f32_16x16x32_bf16 v[96:99], v[132:135], v[120:123], 0
    ds_read_b64 v[180:181], v20 offset:10240
    ds_read_b64 v[182:183], v21 offset:10240
    s_waitcnt lgkmcnt(10)
    v_mfma_f32_16x16x32_bf16 v[64:67], v[148:151], v[136:139], v[64:67]
    v_cvt_pk_bf16_f32 v184, v184, v185
    v_cvt_pk_bf16_f32 v185, v186, v187
    v_mfma_f32_16x16x32_bf16 v[76:79], v[148:151], v[140:143], v[76:79]
    v_cvt_pk_bf16_f32 v186, v196, v197
    v_cvt_pk_bf16_f32 v187, v198, v199
    v_mfma_f32_16x16x32_bf16 v[88:91], v[148:151], v[144:147], v[88:91]
    ds_read_b64 v[196:197], v22 offset:6144
    ds_read_b64 v[198:199], v23 offset:6144
    s_waitcnt lgkmcnt(10)
    v_mfma_f32_16x16x32_bf16 v[68:71], v[152:155], v[136:139], v[68:71]
    v_cvt_pk_bf16_f32 v188, v188, v189
    v_cvt_pk_bf16_f32 v189, v190, v191
    v_mfma_f32_16x16x32_bf16 v[80:83], v[152:155], v[140:143], v[80:83]
    v_cvt_pk_bf16_f32 v190, v200, v201
    v_cvt_pk_bf16_f32 v191, v202, v203
    v_mfma_f32_16x16x32_bf16 v[92:95], v[152:155], v[144:147], v[92:95]
    ds_read_b64 v[200:201], v22 offset:8192
    ds_read_b64 v[202:203], v23 offset:8192
    s_waitcnt lgkmcnt(10)
    v_mfma_f32_16x16x32_bf16 v[72:75], v[156:159], v[136:139], v[72:75]
    v_cvt_pk_bf16_f32 v192, v192, v193
    v_cvt_pk_bf16_f32 v193, v194, v195
    v_mfma_f32_16x16x32_bf16 v[84:87], v[156:159], v[140:143], v[84:87]
    v_cvt_pk_bf16_f32 v194, v204, v205
    v_cvt_pk_bf16_f32 v195, v206, v207
    v_mfma_f32_16x16x32_bf16 v[96:99], v[156:159], v[144:147], v[96:99]
    ds_read_b64 v[204:205], v22 offset:10240
    ds_read_b64 v[206:207], v23 offset:10240
    s_waitcnt lgkmcnt(10)
    v_mfma_f32_16x16x32_bf16 v[64:67], v[172:175], v[160:163], v[64:67]
    v_cvt_pk_bf16_f32 v208, v208, v209
    v_cvt_pk_bf16_f32 v209, v210, v211
    v_mfma_f32_16x16x32_bf16 v[76:79], v[172:175], v[164:167], v[76:79]
    v_cvt_pk_bf16_f32 v210, v220, v221
    v_cvt_pk_bf16_f32 v211, v222, v223
    v_mfma_f32_16x16x32_bf16 v[88:91], v[172:175], v[168:171], v[88:91]
    ds_read_b64 v[220:221], v20 offset:12288
    ds_read_b64 v[222:223], v21 offset:12288
    s_waitcnt lgkmcnt(10)
    v_mfma_f32_16x16x32_bf16 v[68:71], v[176:179], v[160:163], v[68:71]
    v_cvt_pk_bf16_f32 v212, v212, v213
    v_cvt_pk_bf16_f32 v213, v214, v215
    v_mfma_f32_16x16x32_bf16 v[80:83], v[176:179], v[164:167], v[80:83]
    v_cvt_pk_bf16_f32 v214, v224, v225
    v_cvt_pk_bf16_f32 v215, v226, v227
    v_mfma_f32_16x16x32_bf16 v[92:95], v[176:179], v[168:171], v[92:95]
    ds_read_b64 v[224:225], v20 offset:14336
    ds_read_b64 v[226:227], v21 offset:14336
    s_waitcnt lgkmcnt(10)
    v_mfma_f32_16x16x32_bf16 v[72:75], v[180:183], v[160:163], v[72:75]
    v_cvt_pk_bf16_f32 v216, v216, v217
    v_cvt_pk_bf16_f32 v217, v218, v219
    v_mfma_f32_16x16x32_bf16 v[84:87], v[180:183], v[164:167], v[84:87]
    v_cvt_pk_bf16_f32 v218, v228, v229
    v_cvt_pk_bf16_f32 v219, v230, v231
    v_mfma_f32_16x16x32_bf16 v[96:99], v[180:183], v[168:171], v[96:99]
    ds_read_b64 v[228:229], v20 offset:16384
    ds_read_b64 v[230:231], v21 offset:16384
    s_waitcnt lgkmcnt(10)
    v_mfma_f32_16x16x32_bf16 v[64:67], v[196:199], v[184:187], v[64:67]
    v_cvt_pk_bf16_f32 v232, v232, v233
    v_cvt_pk_bf16_f32 v233, v234, v235
    v_mfma_f32_16x16x32_bf16 v[76:79], v[196:199], v[188:191], v[76:79]
    v_cvt_pk_bf16_f32 v234, v244, v245
    v_cvt_pk_bf16_f32 v235, v246, v247
    v_mfma_f32_16x16x32_bf16 v[88:91], v[196:199], v[192:195], v[88:91]
    ds_read_b64 v[244:245], v22 offset:12288
    ds_read_b64 v[246:247], v23 offset:12288
    s_waitcnt lgkmcnt(10)
    v_mfma_f32_16x16x32_bf16 v[68:71], v[200:203], v[184:187], v[68:71]
    v_cvt_pk_bf16_f32 v236, v236, v237
    v_cvt_pk_bf16_f32 v237, v238, v239
    v_mfma_f32_16x16x32_bf16 v[80:83], v[200:203], v[188:191], v[80:83]
    v_cvt_pk_bf16_f32 v238, v248, v249
    v_cvt_pk_bf16_f32 v239, v250, v251
    v_mfma_f32_16x16x32_bf16 v[92:95], v[200:203], v[192:195], v[92:95]
    ds_read_b64 v[248:249], v22 offset:14336
    ds_read_b64 v[250:251], v23 offset:14336
    s_waitcnt lgkmcnt(10)
    v_mfma_f32_16x16x32_bf16 v[72:75], v[204:207], v[184:187], v[72:75]
    v_cvt_pk_bf16_f32 v240, v240, v241
    v_cvt_pk_bf16_f32 v241, v242, v243
    v_mfma_f32_16x16x32_bf16 v[84:87], v[204:207], v[188:191], v[84:87]
    v_cvt_pk_bf16_f32 v242, v252, v253
    v_cvt_pk_bf16_f32 v243, v254, v255
    v_mfma_f32_16x16x32_bf16 v[96:99], v[204:207], v[192:195], v[96:99]
    ds_read_b64 v[252:253], v22 offset:16384
    ds_read_b64 v[254:255], v23 offset:16384
    v_mov_b32 v34, 11
    ds_write_b32 v32, v34
    s_waitcnt lgkmcnt(11)
    v_mfma_f32_16x16x32_bf16 v[64:67], v[220:223], v[208:211], v[64:67]
    v_mfma_f32_16x16x32_bf16 v[76:79], v[220:223], v[212:215], v[76:79]
    v_mfma_f32_16x16x32_bf16 v[88:91], v[220:223], v[216:219], v[88:91]
    s_waitcnt lgkmcnt(9)
    v_mfma_f32_16x16x32_bf16 v[68:71], v[224:227], v[208:211], v[68:71]
    v_mfma_f32_16x16x32_bf16 v[80:83], v[224:227], v[212:215], v[80:83]
    v_mfma_f32_16x16x32_bf16 v[92:95], v[224:227], v[216:219], v[92:95]
    s_waitcnt lgkmcnt(7)
    v_mfma_f32_16x16x32_bf16 v[72:75], v[228:231], v[208:211], v[72:75]
    v_mfma_f32_16x16x32_bf16 v[84:87], v[228:231], v[212:215], v[84:87]
    v_mfma_f32_16x16x32_bf16 v[96:99], v[228:231], v[216:219], v[96:99]
    s_waitcnt lgkmcnt(5)
    v_mfma_f32_16x16x32_bf16 v[64:67], v[244:247], v[232:235], v[64:67]
    v_mfma_f32_16x16x32_bf16 v[76:79], v[244:247], v[236:239], v[76:79]
    v_mfma_f32_16x16x32_bf16 v[88:91], v[244:247], v[240:243], v[88:91]
    s_waitcnt lgkmcnt(3)
    v_mfma_f32_16x16x32_bf16 v[68:71], v[248:251], v[232:235], v[68:71]
    v_mfma_f32_16x16x32_bf16 v[80:83], v[248:251], v[236:239], v[80:83]
    v_mfma_f32_16x16x32_bf16 v[92:95], v[248:251], v[240:243], v[92:95]
    s_waitcnt lgkmcnt(1)
    v_mfma_f32_16x16x32_bf16 v[72:75], v[252:255], v[232:235], v[72:75]
    v_mfma_f32_16x16x32_bf16 v[84:87], v[252:255], v[236:239], v[84:87]
    v_mfma_f32_16x16x32_bf16 v[96:99], v[252:255], v[240:243], v[96:99]
    s_nop 7
    s_mov_b32 s50, 0x3dd53b95
    s_mov_b32 s51, s50
    v_max3_f32 v100, v64, v65, v66
    v_max3_f32 v102, v76, v77, v78
    v_max3_f32 v104, v88, v89, v90
    v_max3_f32 v100, v100, v67, v68
    v_max3_f32 v102, v102, v79, v80
    v_max3_f32 v104, v104, v91, v92
    v_max3_f32 v100, v100, v69, v70
    v_max3_f32 v102, v102, v81, v82
    v_max3_f32 v104, v104, v93, v94
    v_max3_f32 v100, v100, v71, v72
    v_max3_f32 v102, v102, v83, v84
    v_max3_f32 v104, v104, v95, v96
    v_max3_f32 v100, v100, v73, v74
    v_max3_f32 v102, v102, v85, v86
    v_max3_f32 v104, v104, v97, v98
    v_max_f32 v100, v100, v75
    v_max_f32 v102, v102, v87
    v_max_f32 v104, v104, v99
    v_mov_b32 v101, v100
    v_mov_b32 v103, v102
    v_mov_b32 v105, v104
    v_permlane16_swap_b32 v100, v101
    v_permlane16_swap_b32 v102, v103
    v_permlane16_swap_b32 v104, v105
    v_max_f32 v100, v100, v101
    v_max_f32 v102, v102, v103
    v_max_f32 v104, v104, v105
    v_mov_b32 v101, v100
    v_mov_b32 v103, v102
    v_mov_b32 v105, v104
    v_permlane32_swap_b32 v100, v101
    v_permlane32_swap_b32 v102, v103
    v_permlane32_swap_b32 v104, v105
    v_max_f32 v100, v100, v101
    v_max_f32 v102, v102, v103
    v_max_f32 v104, v104, v105
    v_mul_f32 v100, s50, v100
    v_mul_f32 v102, s50, v102
    v_mul_f32 v104, s50, v104
    v_mov_b32 v101, v100
    v_mov_b32 v103, v102
    v_mov_b32 v105, v104
    v_pk_fma_f32 v[64:65], v[64:65], s[50:51], v[100:101] neg_lo:[0,0,1] neg_hi:[0,0,1]
    v_pk_fma_f32 v[76:77], v[76:77], s[50:51], v[102:103] neg_lo:[0,0,1] neg_hi:[0,0,1]
    v_pk_fma_f32 v[88:89], v[88:89], s[50:51], v[104:105] neg_lo:[0,0,1] neg_hi:[0,0,1]
    v_pk_fma_f32 v[66:67], v[66:67], s[50:51], v[100:101] neg_lo:[0,0,1] neg_hi:[0,0,1]
    v_pk_fma_f32 v[78:79], v[78:79], s[50:51], v[102:103] neg_lo:[0,0,1] neg_hi:[0,0,1]
    v_pk_fma_f32 v[90:91], v[90:91], s[50:51], v[104:105] neg_lo:[0,0,1] neg_hi:[0,0,1]
    v_pk_fma_f32 v[68:69], v[68:69], s[50:51], v[100:101] neg_lo:[0,0,1] neg_hi:[0,0,1]
    v_pk_fma_f32 v[80:81], v[80:81], s[50:51], v[102:103] neg_lo:[0,0,1] neg_hi:[0,0,1]
    v_pk_fma_f32 v[92:93], v[92:93], s[50:51], v[104:105] neg_lo:[0,0,1] neg_hi:[0,0,1]
    v_pk_fma_f32 v[70:71], v[70:71], s[50:51], v[100:101] neg_lo:[0,0,1] neg_hi:[0,0,1]
    v_pk_fma_f32 v[82:83], v[82:83], s[50:51], v[102:103] neg_lo:[0,0,1] neg_hi:[0,0,1]
    v_pk_fma_f32 v[94:95], v[94:95], s[50:51], v[104:105] neg_lo:[0,0,1] neg_hi:[0,0,1]
    v_pk_fma_f32 v[72:73], v[72:73], s[50:51], v[100:101] neg_lo:[0,0,1] neg_hi:[0,0,1]
    v_pk_fma_f32 v[84:85], v[84:85], s[50:51], v[102:103] neg_lo:[0,0,1] neg_hi:[0,0,1]
    v_pk_fma_f32 v[96:97], v[96:97], s[50:51], v[104:105] neg_lo:[0,0,1] neg_hi:[0,0,1]
    v_pk_fma_f32 v[74:75], v[74:75], s[50:51], v[100:101] neg_lo:[0,0,1] neg_hi:[0,0,1]
    v_pk_fma_f32 v[86:87], v[86:87], s[50:51], v[102:103] neg_lo:[0,0,1] neg_hi:[0,0,1]
    v_pk_fma_f32 v[98:99], v[98:99], s[50:51], v[104:105] neg_lo:[0,0,1] neg_hi:[0,0,1]
    v_exp_f32 v64, v64
    v_exp_f32 v76, v76
    v_exp_f32 v88, v88
    v_exp_f32 v65, v65
    v_exp_f32 v77, v77
    v_exp_f32 v89, v89
    v_exp_f32 v66, v66
    v_exp_f32 v78, v78
    v_exp_f32 v90, v90
    v_exp_f32 v67, v67
    v_exp_f32 v79, v79
    v_exp_f32 v91, v91
    v_exp_f32 v68, v68
    v_exp_f32 v80, v80
    v_exp_f32 v92, v92
    v_exp_f32 v69, v69
    v_exp_f32 v81, v81
    v_exp_f32 v93, v93
    v_exp_f32 v70, v70
    v_exp_f32 v82, v82
    v_exp_f32 v94, v94
    v_exp_f32 v71, v71
    v_exp_f32 v83, v83
    v_exp_f32 v95, v95
    v_exp_f32 v72, v72
    v_exp_f32 v84, v84
    v_exp_f32 v96, v96
    v_exp_f32 v73, v73
    v_exp_f32 v85, v85
    v_exp_f32 v97, v97
    v_exp_f32 v74, v74
    v_exp_f32 v86, v86
    v_exp_f32 v98, v98
    v_exp_f32 v75, v75
    v_exp_f32 v87, v87
    v_exp_f32 v99, v99
    v_pk_add_f32 v[100:101], v[64:65], v[66:67]
    v_pk_add_f32 v[102:103], v[76:77], v[78:79]
    v_pk_add_f32 v[104:105], v[88:89], v[90:91]
    v_pk_add_f32 v[100:101], v[100:101], v[68:69]
    v_pk_add_f32 v[102:103], v[102:103], v[80:81]
    v_pk_add_f32 v[104:105], v[104:105], v[92:93]
    v_pk_add_f32 v[100:101], v[100:101], v[70:71]
    v_pk_add_f32 v[102:103], v[102:103], v[82:83]
    v_pk_add_f32 v[104:105], v[104:105], v[94:95]
    v_pk_add_f32 v[100:101], v[100:101], v[72:73]
    v_pk_add_f32 v[102:103], v[102:103], v[84:85]
    v_pk_add_f32 v[104:105], v[104:105], v[96:97]
    v_pk_add_f32 v[100:101], v[100:101], v[74:75]
    v_pk_add_f32 v[102:103], v[102:103], v[86:87]
    v_pk_add_f32 v[104:105], v[104:105], v[98:99]
    v_add_f32 v100, v100, v101
    v_add_f32 v102, v102, v103
    v_add_f32 v104, v104, v105
    v_mov_b32 v101, v100
    v_mov_b32 v103, v102
    v_mov_b32 v105, v104
    v_permlane16_swap_b32 v100, v101
    v_permlane16_swap_b32 v102, v103
    v_permlane16_swap_b32 v104, v105
    v_add_f32 v100, v100, v101
    v_add_f32 v102, v102, v103
    v_add_f32 v104, v104, v105
    v_mov_b32 v101, v100
    v_mov_b32 v103, v102
    v_mov_b32 v105, v104
    v_permlane32_swap_b32 v100, v101
    v_permlane32_swap_b32 v102, v103
    v_permlane32_swap_b32 v104, v105
    v_add_f32 v100, v100, v101
    v_add_f32 v102, v102, v103
    v_add_f32 v104, v104, v105
    v_rcp_f32 v100, v100
    v_rcp_f32 v102, v102
    v_rcp_f32 v104, v104
    v_mov_b32 v101, v100
    v_mov_b32 v103, v102
    v_mov_b32 v105, v104
    v_pk_mul_f32 v[64:65], v[64:65], v[100:101]
    v_pk_mul_f32 v[76:77], v[76:77], v[102:103]
    v_pk_mul_f32 v[88:89], v[88:89], v[104:105]
    v_pk_mul_f32 v[66:67], v[66:67], v[100:101]
    v_pk_mul_f32 v[78:79], v[78:79], v[102:103]
    v_pk_mul_f32 v[90:91], v[90:91], v[104:105]
    v_pk_mul_f32 v[68:69], v[68:69], v[100:101]
    v_pk_mul_f32 v[80:81], v[80:81], v[102:103]
    v_pk_mul_f32 v[92:93], v[92:93], v[104:105]
    v_pk_mul_f32 v[70:71], v[70:71], v[100:101]
    v_pk_mul_f32 v[82:83], v[82:83], v[102:103]
    v_pk_mul_f32 v[94:95], v[94:95], v[104:105]
    v_pk_mul_f32 v[72:73], v[72:73], v[100:101]
    v_pk_mul_f32 v[84:85], v[84:85], v[102:103]
    v_pk_mul_f32 v[96:97], v[96:97], v[104:105]
    v_pk_mul_f32 v[74:75], v[74:75], v[100:101]
    v_pk_mul_f32 v[86:87], v[86:87], v[102:103]
    v_pk_mul_f32 v[98:99], v[98:99], v[104:105]
    v_cvt_pk_bf16_f32 v64, v64, v65
    v_cvt_pk_bf16_f32 v76, v76, v77
    v_cvt_pk_bf16_f32 v88, v88, v89
    v_cvt_pk_bf16_f32 v65, v66, v67
    v_cvt_pk_bf16_f32 v77, v78, v79
    v_cvt_pk_bf16_f32 v89, v90, v91
    v_cvt_pk_bf16_f32 v66, v68, v69
    v_cvt_pk_bf16_f32 v78, v80, v81
    v_cvt_pk_bf16_f32 v90, v92, v93
    v_cvt_pk_bf16_f32 v67, v70, v71
    v_cvt_pk_bf16_f32 v79, v82, v83
    v_cvt_pk_bf16_f32 v91, v94, v95
    v_cvt_pk_bf16_f32 v68, v72, v73
    v_cvt_pk_bf16_f32 v80, v84, v85
    v_cvt_pk_bf16_f32 v92, v96, v97
    v_cvt_pk_bf16_f32 v69, v74, v75
    v_cvt_pk_bf16_f32 v81, v86, v87
    v_cvt_pk_bf16_f32 v93, v98, v99
    s_mov_b32 s96, 0
lw_52:
    ds_read_b128 v[28:31], v33 offset:0
    s_add_u32 s96, s96, 1
    s_waitcnt lgkmcnt(0)
    v_min3_u32 v28, v28, v29, v30
    v_min_u32 v28, v28, v31
    s_nop 0
    v_readfirstlane_b32 s53, v28
    s_nop 0
    s_cmp_ge_u32 s53, 12
    s_cbranch_scc1 lwok_53
    s_cmp_lt_u32 s96, 2000000
    s_cbranch_scc1 lw_52
lwok_53:
    ds_read_b64_tr_b16 v[112:113], v24 offset:0
    ds_read_b64_tr_b16 v[114:115], v24 offset:2048
    ds_read_b64_tr_b16 v[116:117], v24 offset:4096
    ds_read_b64_tr_b16 v[120:121], v25 offset:0
    ds_read_b64_tr_b16 v[122:123], v25 offset:2048
    ds_read_b64_tr_b16 v[124:125], v25 offset:4096
    ds_read_b64_tr_b16 v[128:129], v26 offset:0
    ds_read_b64_tr_b16 v[130:131], v26 offset:2048
    ds_read_b64_tr_b16 v[132:133], v26 offset:4096
    s_waitcnt lgkmcnt(6)
    v_mfma_f32_16x16x32_bf16 v[144:147], v[112:115], v[64:67], 0
    ds_read_b64_tr_b16 v[136:137], v27 offset:0
    v_mfma_f32_16x16x32_bf16 v[148:151], v[112:115], v[76:79], 0
    ds_read_b64_tr_b16 v[138:139], v27 offset:2048
    v_mfma_f32_16x16x32_bf16 v[152:155], v[112:115], v[88:91], 0
    ds_read_b64_tr_b16 v[140:141], v27 offset:4096
    v_mfma_f32_16x16x16_bf16 v[144:147], v[116:117], v[68:69], v[144:147]
    v_mov_b32 v34, 12
    v_mfma_f32_16x16x16_bf16 v[148:151], v[116:117], v[80:81], v[148:151]
    ds_write_b32 v32, v34
    v_mfma_f32_16x16x16_bf16 v[152:155], v[116:117], v[92:93], v[152:155]
    s_waitcnt lgkmcnt(7)
    v_mfma_f32_16x16x32_bf16 v[156:159], v[120:123], v[64:67], 0
    ds_read_b128 v[28:31], v33 offset:0
    s_nop 0
    s_nop 0
    v_mfma_f32_16x16x32_bf16 v[160:163], v[120:123], v[76:79], 0
    s_waitcnt lgkmcnt(0)
    v_min3_u32 v28, v28, v29, v30
    v_min_u32 v28, v28, v31
    v_mfma_f32_16x16x32_bf16 v[164:167], v[120:123], v[88:91], 0
    s_nop 0
    v_readfirstlane_b32 s53, v28
    v_mfma_f32_16x16x16_bf16 v[156:159], v[124:125], v[68:69], v[156:159]
    s_nop 0
    s_cmp_ge_u32 s53, 13
    s_cbranch_scc0 spin_54
ret_55:
    v_mfma_f32_16x16x16_bf16 v[160:163], v[124:125], v[80:81], v[160:163]
    ds_read_b64_tr_b16 v[112:113], v24 offset:24576
    ds_read_b64_tr_b16 v[114:115], v24 offset:26624
    v_mfma_f32_16x16x16_bf16 v[164:167], v[124:125], v[92:93], v[164:167]
    ds_read_b64_tr_b16 v[116:117], v24 offset:28672
    v_mfma_f32_16x16x32_bf16 v[168:171], v[128:131], v[64:67], 0
    ds_read_b64_tr_b16 v[120:121], v25 offset:24576
    v_mfma_f32_16x16x32_bf16 v[172:175], v[128:131], v[76:79], 0
    ds_read_b64_tr_b16 v[122:123], v25 offset:26624
    v_mfma_f32_16x16x32_bf16 v[176:179], v[128:131], v[88:91], 0
    ds_read_b64_tr_b16 v[124:125], v25 offset:28672
    v_cvt_pk_bf16_f32 v192, v144, v145
    v_cvt_pk_bf16_f32 v193, v146, v147
    v_cvt_pk_bf16_f32 v194, v156, v157
    v_mfma_f32_16x16x16_bf16 v[168:171], v[132:133], v[68:69], v[168:171]
    v_cvt_pk_bf16_f32 v195, v158, v159
    v_cvt_pk_bf16_f32 v196, v148, v149
    v_cvt_pk_bf16_f32 v197, v150, v151
    v_mfma_f32_16x16x16_bf16 v[172:175], v[132:133], v[80:81], v[172:175]
    v_cvt_pk_bf16_f32 v198, v160, v161
    v_cvt_pk_bf16_f32 v199, v162, v163
    v_cvt_pk_bf16_f32 v200, v152, v153
    v_mfma_f32_16x16x16_bf16 v[176:179], v[132:133], v[92:93], v[176:179]
    v_cvt_pk_bf16_f32 v201, v154, v155
    v_cvt_pk_bf16_f32 v202, v164, v165
    v_cvt_pk_bf16_f32 v203, v166, v167
    v_mfma_f32_16x16x32_bf16 v[180:183], v[136:139], v[64:67], 0
    ds_read_b64_tr_b16 v[128:129], v26 offset:24576
    ds_read_b64_tr_b16 v[130:131], v26 offset:26624
    ds_read_b64_tr_b16 v[132:133], v26 offset:28672
    v_mfma_f32_16x16x32_bf16 v[184:187], v[136:139], v[76:79], 0
    ds_read_b128 v[28:31], v33 offset:16
    s_nop 0
    s_nop 0
    v_mfma_f32_16x16x32_bf16 v[188:191], v[136:139], v[88:91], 0
    s_waitcnt lgkmcnt(0)
    v_min3_u32 v28, v28, v29, v30
    v_min_u32 v28, v28, v31
    s_nop 0
    v_mfma_f32_16x16x16_bf16 v[180:183], v[140:141], v[68:69], v[180:183]
    v_readfirstlane_b32 s53, v28
    s_nop 0
    v_mfma_f32_16x16x16_bf16 v[184:187], v[140:141], v[80:81], v[184:187]
    s_cmp_ge_u32 s53, 12
    s_cbranch_scc0 spin_56
ret_57:
    ds_write_b128 v8, v[192:195] offset:0
    v_mfma_f32_16x16x16_bf16 v[188:191], v[140:141], v[92:93], v[188:191]
    ds_write_b128 v8, v[196:199] offset:1024
    ds_write_b128 v8, v[200:203] offset:2048
    v_mfma_f32_16x16x32_bf16 v[144:147], v[112:115], v[64:67], 0
    ds_read_b64_tr_b16 v[136:137], v27 offset:24576
    v_mfma_f32_16x16x32_bf16 v[148:151], v[112:115], v[76:79], 0
    ds_read_b64_tr_b16 v[138:139], v27 offset:26624
    v_mfma_f32_16x16x32_bf16 v[152:155], v[112:115], v[88:91], 0
    ds_read_b64_tr_b16 v[140:141], v27 offset:28672
    v_mov_b32 v34, 13
    ds_write_b32 v32, v34
    v_cvt_pk_bf16_f32 v204, v168, v169
    v_mfma_f32_16x16x16_bf16 v[144:147], v[116:117], v[68:69], v[144:147]
    v_cvt_pk_bf16_f32 v205, v170, v171
    v_cvt_pk_bf16_f32 v206, v180, v181
    v_cvt_pk_bf16_f32 v207, v182, v183
    v_cvt_pk_bf16_f32 v208, v172, v173
    v_mfma_f32_16x16x16_bf16 v[148:151], v[116:117], v[80:81], v[148:151]
    v_cvt_pk_bf16_f32 v209, v174, v175
    v_cvt_pk_bf16_f32 v210, v184, v185
    v_cvt_pk_bf16_f32 v211, v186, v187
    v_cvt_pk_bf16_f32 v212, v176, v177
    v_mfma_f32_16x16x16_bf16 v[152:155], v[116:117], v[92:93], v[152:155]
    v_cvt_pk_bf16_f32 v213, v178, v179
    v_cvt_pk_bf16_f32 v214, v188, v189
    v_cvt_pk_bf16_f32 v215, v190, v191
    v_mfma_f32_16x16x32_bf16 v[156:159], v[120:123], v[64:67], 0
    ds_read_b128 v[28:31], v33 offset:0
    s_nop 0
    s_nop 0
    v_mfma_f32_16x16x32_bf16 v[160:163], v[120:123], v[76:79], 0
    s_waitcnt lgkmcnt(0)
    v_min3_u32 v28, v28, v29, v30
    v_min_u32 v28, v28, v31
    s_nop 0
    v_mfma_f32_16x16x32_bf16 v[164:167], v[120:123], v[88:91], 0
    v_readfirstlane_b32 s53, v28
    s_nop 0
    s_cmp_ge_u32 s53, 14
    s_cbranch_scc0 spin_58
ret_59:
    v_mfma_f32_16x16x16_bf16 v[156:159], v[124:125], v[68:69], v[156:159]
    ds_read_b64_tr_b16 v[112:113], v24 offset:49152
    ds_read_b64_tr_b16 v[114:115], v24 offset:51200
    ds_read_b64_tr_b16 v[116:117], v24 offset:53248
    v_mfma_f32_16x16x16_bf16 v[160:163], v[124:125], v[80:81], v[160:163]
    ds_write_b128 v8, v[204:207] offset:12288
    ds_write_b128 v8, v[208:211] offset:13312
    ds_write_b128 v8, v[212:215] offset:14336
    v_mfma_f32_16x16x16_bf16 v[164:167], v[124:125], v[92:93], v[164:167]
    v_mov_b32 v34, 14
    ds_write_b32 v32, v34
    v_mfma_f32_16x16x32_bf16 v[168:171], v[128:131], v[64:67], 0
    ds_read_b64_tr_b16 v[120:121], v25 offset:49152
    v_mfma_f32_16x16x32_bf16 v[172:175], v[128:131], v[76:79], 0
    ds_read_b64_tr_b16 v[122:123], v25 offset:51200
    v_mfma_f32_16x16x32_bf16 v[176:179], v[128:131], v[88:91], 0
    ds_read_b64_tr_b16 v[124:125], v25 offset:53248
    v_cvt_pk_bf16_f32 v192, v144, v145
    v_cvt_pk_bf16_f32 v193, v146, v147
    v_cvt_pk_bf16_f32 v194, v156, v157
    v_mfma_f32_16x16x16_bf16 v[168:171], v[132:133], v[68:69], v[168:171]
    v_cvt_pk_bf16_f32 v195, v158, v159
    v_cvt_pk_bf16_f32 v196, v148, v149
    v_cvt_pk_bf16_f32 v197, v150, v151
    v_mfma_f32_16x16x16_bf16 v[172:175], v[132:133], v[80:81], v[172:175]
    v_cvt_pk_bf16_f32 v198, v160, v161
    v_cvt_pk_bf16_f32 v199, v162, v163
    v_cvt_pk_bf16_f32 v200, v152, v153
    v_mfma_f32_16x16x16_bf16 v[176:179], v[132:133], v[92:93], v[176:179]
    v_cvt_pk_bf16_f32 v201, v154, v155
    v_cvt_pk_bf16_f32 v202, v164, v165
    v_cvt_pk_bf16_f32 v203, v166, v167
    v_mfma_f32_16x16x32_bf16 v[180:183], v[136:139], v[64:67], 0
    ds_read_b64_tr_b16 v[128:129], v26 offset:49152
    ds_read_b64_tr_b16 v[130:131], v26 offset:51200
    ds_read_b64_tr_b16 v[132:133], v26 offset:53248
    v_mfma_f32_16x16x32_bf16 v[184:187], v[136:139], v[76:79], 0
    ds_read_b128 v[28:31], v33 offset:16
    s_nop 0
    s_nop 0
    v_mfma_f32_16x16x32_bf16 v[188:191], v[136:139], v[88:91], 0
    s_waitcnt lgkmcnt(0)
    v_min3_u32 v28, v28, v29, v30
    v_min_u32 v28, v28, v31
    s_nop 0
    v_mfma_f32_16x16x16_bf16 v[180:183], v[140:141], v[68:69], v[180:183]
    v_readfirstlane_b32 s53, v28
    s_nop 0
    v_mfma_f32_16x16x16_bf16 v[184:187], v[140:141], v[80:81], v[184:187]
    s_cmp_ge_u32 s53, 13
    s_cbranch_scc0 spin_60
ret_61:
    ds_write_b128 v8, v[192:195] offset:24576
    v_mfma_f32_16x16x16_bf16 v[188:191], v[140:141], v[92:93], v[188:191]
    ds_write_b128 v8, v[196:199] offset:25600
    ds_write_b128 v8, v[200:203] offset:26624
    v_mfma_f32_16x16x32_bf16 v[144:147], v[112:115], v[64:67], 0
    ds_read_b64_tr_b16 v[136:137], v27 offset:49152
    v_mfma_f32_16x16x32_bf16 v[148:151], v[112:115], v[76:79], 0
    ds_read_b64_tr_b16 v[138:139], v27 offset:51200
    v_mfma_f32_16x16x32_bf16 v[152:155], v[112:115], v[88:91], 0
    ds_read_b64_tr_b16 v[140:141], v27 offset:53248
    v_mov_b32 v34, 15
    ds_write_b32 v32, v34
    v_cvt_pk_bf16_f32 v204, v168, v169
    v_mfma_f32_16x16x16_bf16 v[144:147], v[116:117], v[68:69], v[144:147]
    v_cvt_pk_bf16_f32 v205, v170, v171
    v_cvt_pk_bf16_f32 v206, v180, v181
    v_cvt_pk_bf16_f32 v207, v182, v183
    v_cvt_pk_bf16_f32 v208, v172, v173
    v_mfma_f32_16x16x16_bf16 v[148:151], v[116:117], v[80:81], v[148:151]
    v_cvt_pk_bf16_f32 v209, v174, v175
    v_cvt_pk_bf16_f32 v210, v184, v185
    v_cvt_pk_bf16_f32 v211, v186, v187
    v_cvt_pk_bf16_f32 v212, v176, v177
    v_mfma_f32_16x16x16_bf16 v[152:155], v[116:117], v[92:93], v[152:155]
    v_cvt_pk_bf16_f32 v213, v178, v179
    v_cvt_pk_bf16_f32 v214, v188, v189
    v_cvt_pk_bf16_f32 v215, v190, v191
    v_mfma_f32_16x16x32_bf16 v[156:159], v[120:123], v[64:67], 0
    ds_write_b128 v8, v[204:207] offset:36864
    v_mfma_f32_16x16x32_bf16 v[160:163], v[120:123], v[76:79], 0
    ds_write_b128 v8, v[208:211] offset:37888
    v_mfma_f32_16x16x32_bf16 v[164:167], v[120:123], v[88:91], 0
    ds_write_b128 v8, v[212:215] offset:38912
    v_mfma_f32_16x16x16_bf16 v[156:159], v[124:125], v[68:69], v[156:159]
    v_mov_b32 v34, 16
    v_mfma_f32_16x16x16_bf16 v[160:163], v[124:125], v[80:81], v[160:163]
    ds_write_b32 v32, v34
    v_mfma_f32_16x16x16_bf16 v[164:167], v[124:125], v[92:93], v[164:167]
    v_mfma_f32_16x16x32_bf16 v[168:171], v[128:131], v[64:67], 0
    v_mfma_f32_16x16x32_bf16 v[172:175], v[128:131], v[76:79], 0
    v_mfma_f32_16x16x32_bf16 v[176:179], v[128:131], v[88:91], 0
    v_cvt_pk_bf16_f32 v192, v144, v145
    v_cvt_pk_bf16_f32 v193, v146, v147
    v_cvt_pk_bf16_f32 v194, v156, v157
    v_mfma_f32_16x16x16_bf16 v[168:171], v[132:133], v[68:69], v[168:171]
    v_cvt_pk_bf16_f32 v195, v158, v159
    v_cvt_pk_bf16_f32 v196, v148, v149
    v_cvt_pk_bf16_f32 v197, v150, v151
    v_mfma_f32_16x16x16_bf16 v[172:175], v[132:133], v[80:81], v[172:175]
    v_cvt_pk_bf16_f32 v198, v160, v161
    v_cvt_pk_bf16_f32 v199, v162, v163
    v_cvt_pk_bf16_f32 v200, v152, v153
    v_mfma_f32_16x16x16_bf16 v[176:179], v[132:133], v[92:93], v[176:179]
    v_cvt_pk_bf16_f32 v201, v154, v155
    v_cvt_pk_bf16_f32 v202, v164, v165
    v_cvt_pk_bf16_f32 v203, v166, v167
    s_waitcnt lgkmcnt(5)
    v_mfma_f32_16x16x32_bf16 v[180:183], v[136:139], v[64:67], 0
    ds_read_b128 v[28:31], v33 offset:16
    s_nop 0
    s_nop 0
    v_mfma_f32_16x16x32_bf16 v[184:187], v[136:139], v[76:79], 0
    s_waitcnt lgkmcnt(0)
    v_min3_u32 v28, v28, v29, v30
    v_min_u32 v28, v28, v31
    v_mfma_f32_16x16x32_bf16 v[188:191], v[136:139], v[88:91], 0
    s_nop 0
    v_readfirstlane_b32 s53, v28
    v_mfma_f32_16x16x16_bf16 v[180:183], v[140:141], v[68:69], v[180:183]
    s_nop 0
    s_cmp_ge_u32 s53, 15
    s_cbranch_scc0 spin_62
ret_63:
    v_mfma_f32_16x16x16_bf16 v[184:187], v[140:141], v[80:81], v[184:187]
    ds_write_b128 v8, v[192:195] offset:49152
    ds_write_b128 v8, v[196:199] offset:50176
    v_mfma_f32_16x16x16_bf16 v[188:191], v[140:141], v[92:93], v[188:191]
    ds_write_b128 v8, v[200:203] offset:51200
    s_nop 7
    v_cvt_pk_bf16_f32 v204, v168, v169
    v_cvt_pk_bf16_f32 v205, v170, v171
    v_cvt_pk_bf16_f32 v206, v180, v181
    v_cvt_pk_bf16_f32 v207, v182, v183
    v_cvt_pk_bf16_f32 v208, v172, v173
    v_cvt_pk_bf16_f32 v209, v174, v175
    v_cvt_pk_bf16_f32 v210, v184, v185
    v_cvt_pk_bf16_f32 v211, v186, v187
    v_cvt_pk_bf16_f32 v212, v176, v177
    v_cvt_pk_bf16_f32 v213, v178, v179
    v_cvt_pk_bf16_f32 v214, v188, v189
    v_cvt_pk_bf16_f32 v215, v190, v191
    ds_write_b128 v8, v[204:207] offset:61440
    ds_write_b128 v8, v[208:211] offset:62464
    ds_write_b128 v8, v[212:215] offset:63488
    v_mov_b32 v34, 17
    ds_write_b32 v32, v34
    s_and_b32 s59, s3, 1
    s_lshr_b32 s60, s3, 1
    s_mul_i32 s48, s59, 6144
    v_add_u32 v2, s48, v10
    v_lshl_add_u32 v16, v13, 2, v14
    v_mul_u32_u24 v16, 320, v16
    v_lshl_add_u32 v16, v15, 3, v16
    v_add_u32 v16, 101888, v16
    v_and_b32 v17, 1, v13
    v_lshlrev_b32 v17, 5, v17
    s_mul_i32 s48, s60, 160
    v_xor_b32 v18, s48, v17
    v_add_u32 v3, v16, v18
    s_add_u32 s48, s48, 32
    v_xor_b32 v18, s48, v17
    v_add3_u32 v4, v16, v18, -16
    v_add_u32 v4, -16, v4
    v_add_u32 v5, 36864, v2
    v_mov_b32 v21, 1
    s_mov_b32 s57, 0
    s_mov_b32 s96, 0
lw_64:
    ds_read_b128 v[28:31], v33 offset:0
    s_add_u32 s96, s96, 1
    s_waitcnt lgkmcnt(0)
    v_min3_u32 v28, v28, v29, v30
    v_min_u32 v28, v28, v31
    s_nop 0
    v_readfirstlane_b32 s53, v28
    s_nop 0
    s_cmp_ge_u32 s53, 15
    s_cbranch_scc1 lwok_65
    s_cmp_lt_u32 s96, 2000000
    s_cbranch_scc1 lw_64
lwok_65:
    s_mov_b32 s96, 0
lw_66:
    ds_read_b128 v[28:31], v33 offset:16
    s_add_u32 s96, s96, 1
    s_waitcnt lgkmcnt(0)
    v_min3_u32 v28, v28, v29, v30
    v_min_u32 v28, v28, v31
    s_nop 0
    v_readfirstlane_b32 s53, v28
    s_nop 0
    s_cmp_ge_u32 s53, 17
    s_cbranch_scc1 lwok_67
    s_cmp_lt_u32 s96, 2000000
    s_cbranch_scc1 lw_66
lwok_67:
    ds_read_b128 v[40:43], v2 offset:0
    ds_read_b64_tr_b16 v[64:65], v3 offset:0
    ds_read_b64_tr_b16 v[66:67], v3 offset:5120
    ds_read_b128 v[44:47], v2 offset:1024
    ds_read_b128 v[48:51], v2 offset:2048
    ds_read_b128 v[52:55], v2 offset:3072
    ds_read_b128 v[56:59], v2 offset:4096
    ds_read_b128 v[60:63], v2 offset:5120
    ds_read_b64_tr_b16 v[68:69], v4 offset:32
    ds_read_b64_tr_b16 v[70:71], v4 offset:5152
    ds_read_b64_tr_b16 v[72:73], v3 offset:64
    ds_read_b64_tr_b16 v[74:75], v3 offset:5184
    ds_read_b64_tr_b16 v[76:77], v4 offset:96
    ds_read_b64_tr_b16 v[78:79], v4 offset:5216
    ds_read_b64_tr_b16 v[80:81], v3 offset:128
    ds_read_b64_tr_b16 v[82:83], v3 offset:5248
    s_waitcnt lgkmcnt(8)
    v_mfma_f32_16x16x32_bf16 v[128:131], v[64:67], v[40:43], 0
    s_lshl_b32 s48, s38, 2
    v_mfma_f32_16x16x32_bf16 v[132:135], v[64:67], v[44:47], 0
    s_add_u32 s48, s48, s41
    v_mfma_f32_16x16x32_bf16 v[136:139], v[64:67], v[48:51], 0
    ds_read_b128 v[84:87], v2 offset:12288
    s_lshl_b32 s48, s48, 2
    v_mfma_f32_16x16x32_bf16 v[140:143], v[64:67], v[52:55], 0
    ds_read_b64_tr_b16 v[108:109], v3 offset:10240
    s_and_b32 s49, s42, 3
    v_mfma_f32_16x16x32_bf16 v[144:147], v[64:67], v[56:59], 0
    ds_read_b64_tr_b16 v[110:111], v3 offset:15360
    s_add_u32 s48, s48, s49
    v_mfma_f32_16x16x32_bf16 v[148:151], v[64:67], v[60:63], 0
    ds_read_b128 v[88:91], v2 offset:13312
    s_lshl_b32 s48, s48, 19
    s_waitcnt lgkmcnt(10)
    v_mfma_f32_16x16x32_bf16 v[152:155], v[68:71], v[40:43], 0
    ds_read_b128 v[92:95], v2 offset:14336
    s_add_u32 s61, s48, 20971520
    v_mfma_f32_16x16x32_bf16 v[156:159], v[68:71], v[44:47], 0
    ds_read_b128 v[96:99], v2 offset:15360
    s_lshl_b32 s48, s3, 17
    v_mfma_f32_16x16x32_bf16 v[160:163], v[68:71], v[48:51], 0
    ds_read_b128 v[100:103], v2 offset:16384
    s_lshl_b32 s49, s55, 13
    v_mfma_f32_16x16x32_bf16 v[164:167], v[68:71], v[52:55], 0
    ds_read_b128 v[104:107], v2 offset:17408
    s_add_u32 s62, s61, s48
    v_mfma_f32_16x16x32_bf16 v[168:171], v[68:71], v[56:59], 0
    ds_read_b64_tr_b16 v[112:113], v4 offset:10272
    s_add_u32 s62, s62, s49
    v_mfma_f32_16x16x32_bf16 v[172:175], v[68:71], v[60:63], 0
    ds_read_b64_tr_b16 v[114:115], v4 offset:15392
    s_and_b32 s48, s42, 3
    s_waitcnt lgkmcnt(14)
    v_mfma_f32_16x16x32_bf16 v[176:179], v[72:75], v[40:43], 0
    ds_read_b64_tr_b16 v[116:117], v3 offset:10304
    s_lshl_b32 s48, s48, 10
    v_mfma_f32_16x16x32_bf16 v[180:183], v[72:75], v[44:47], 0
    ds_read_b64_tr_b16 v[118:119], v3 offset:15424
    s_add_u32 s48, s48, s54
    v_mfma_f32_16x16x32_bf16 v[184:187], v[72:75], v[48:51], 0
    ds_read_b64_tr_b16 v[120:121], v4 offset:10336
    s_add_u32 s63, s48, 1024
    v_mfma_f32_16x16x32_bf16 v[188:191], v[72:75], v[52:55], 0
    ds_read_b64_tr_b16 v[122:123], v4 offset:15456
    s_lshl_b32 s48, s3, 8
    v_mfma_f32_16x16x32_bf16 v[192:195], v[72:75], v[56:59], 0
    ds_read_b64_tr_b16 v[124:125], v3 offset:10368
    s_lshl_b32 s49, s55, 2
    v_mfma_f32_16x16x32_bf16 v[196:199], v[72:75], v[60:63], 0
    ds_read_b64_tr_b16 v[126:127], v3 offset:15488
    s_add_u32 s48, s48, s49
    s_waitcnt lgkmcnt(15)
    v_mfma_f32_16x16x32_bf16 v[200:203], v[76:79], v[40:43], 0
    v_lshlrev_b32 v22, 7, v0
    v_mfma_f32_16x16x32_bf16 v[204:207], v[76:79], v[44:47], 0
    v_add_u32 v22, s48, v22
    v_mfma_f32_16x16x32_bf16 v[208:211], v[76:79], v[48:51], 0
    v_and_b32 v23, 7, v0
    v_mfma_f32_16x16x32_bf16 v[212:215], v[76:79], v[52:55], 0
    v_lshlrev_b32 v23, 2, v23
    v_mfma_f32_16x16x32_bf16 v[216:219], v[76:79], v[56:59], 0
    s_lshl_b32 s49, s55, 7
    v_mfma_f32_16x16x32_bf16 v[220:223], v[76:79], v[60:63], 0
    v_add_u32 v23, s49, v23
    v_mfma_f32_16x16x32_bf16 v[224:227], v[80:83], v[40:43], 0
    s_lshl_b32 s48, s55, 16
    v_mfma_f32_16x16x32_bf16 v[228:231], v[80:83], v[44:47], 0
    s_lshl_b32 s49, s3, 11
    v_mfma_f32_16x16x32_bf16 v[232:235], v[80:83], v[48:51], 0
    s_add_u32 s61, s61, s48
    v_mfma_f32_16x16x32_bf16 v[236:239], v[80:83], v[52:55], 0
    s_add_u32 s61, s61, s49
    v_mfma_f32_16x16x32_bf16 v[240:243], v[80:83], v[56:59], 0
    s_mul_i32 s48, s41, 192
    v_mfma_f32_16x16x32_bf16 v[244:247], v[80:83], v[60:63], 0
    s_and_b32 s49, s55, 3
    s_waitcnt lgkmcnt(8)
    v_mfma_f32_16x16x32_bf16 v[128:131], v[108:111], v[84:87], v[128:131]
    s_mul_i32 s49, s49, 48
    v_mfma_f32_16x16x32_bf16 v[132:135], v[108:111], v[88:91], v[132:135]
    s_add_u32 s48, s48, s49
    v_mfma_f32_16x16x32_bf16 v[136:139], v[108:111], v[92:95], v[136:139]
    ds_read_b128 v[40:43], v2 offset:24576
    s_mul_i32 s48, s48, 2560
    v_mfma_f32_16x16x32_bf16 v[140:143], v[108:111], v[96:99], v[140:143]
    ds_read_b64_tr_b16 v[64:65], v3 offset:20480
    s_mul_i32 s49, s38, 1280
    v_mfma_f32_16x16x32_bf16 v[144:147], v[108:111], v[100:103], v[144:147]
    ds_read_b64_tr_b16 v[66:67], v3 offset:25600
    s_add_u32 s48, s48, s49
    v_mfma_f32_16x16x32_bf16 v[148:151], v[108:111], v[104:107], v[148:151]
    ds_read_b128 v[44:47], v2 offset:25600
    s_and_b32 s49, s42, 3
    s_waitcnt lgkmcnt(10)
    v_mfma_f32_16x16x32_bf16 v[152:155], v[112:115], v[84:87], v[152:155]
    ds_read_b128 v[48:51], v2 offset:26624
    s_mul_i32 s49, s49, 320
    v_mfma_f32_16x16x32_bf16 v[156:159], v[112:115], v[88:91], v[156:159]
    ds_read_b128 v[52:55], v2 offset:27648
    s_add_u32 s48, s48, s49
    v_mfma_f32_16x16x32_bf16 v[160:163], v[112:115], v[92:95], v[160:163]
    ds_read_b128 v[56:59], v2 offset:28672
    s_lshr_b32 s49, s55, 2
    v_mfma_f32_16x16x32_bf16 v[164:167], v[112:115], v[96:99], v[164:167]
    ds_read_b128 v[60:63], v2 offset:29696
    s_mul_i32 s49, s49, 160
    v_mfma_f32_16x16x32_bf16 v[168:171], v[112:115], v[100:103], v[168:171]
    ds_read_b64_tr_b16 v[68:69], v4 offset:20512
    s_add_u32 s58, s48, s49
    v_mfma_f32_16x16x32_bf16 v[172:175], v[112:115], v[104:107], v[172:175]
    ds_read_b64_tr_b16 v[70:71], v4 offset:25632
    v_mul_u32_u24 v9, 2560, v12
    s_waitcnt lgkmcnt(14)
    v_mfma_f32_16x16x32_bf16 v[176:179], v[116:119], v[84:87], v[176:179]
    ds_read_b64_tr_b16 v[72:73], v3 offset:20544
    v_lshl_add_u32 v9, v13, 3, v9
    v_mfma_f32_16x16x32_bf16 v[180:183], v[116:119], v[88:91], v[180:183]
    ds_read_b64_tr_b16 v[74:75], v3 offset:25664
    s_lshl_b32 s48, s3, 2
    v_mfma_f32_16x16x32_bf16 v[184:187], v[116:119], v[92:95], v[184:187]
    ds_read_b64_tr_b16 v[76:77], v4 offset:20576
    s_add_u32 s48, s48, 0
    v_mfma_f32_16x16x32_bf16 v[188:191], v[116:119], v[96:99], v[188:191]
    ds_read_b64_tr_b16 v[78:79], v4 offset:25696
    s_mul_i32 s49, s48, 86
    v_mfma_f32_16x16x32_bf16 v[192:195], v[116:119], v[100:103], v[192:195]
    ds_read_b64_tr_b16 v[80:81], v3 offset:20608
    s_lshr_b32 s49, s49, 8
    v_mfma_f32_16x16x32_bf16 v[196:199], v[116:119], v[104:107], v[196:199]
    ds_read_b64_tr_b16 v[82:83], v3 offset:25728
    s_mul_i32 s50, s49, 3
    s_waitcnt lgkmcnt(15)
    v_mfma_f32_16x16x32_bf16 v[200:203], v[120:123], v[84:87], v[200:203]
    s_sub_u32 s50, s48, s50
    v_mfma_f32_16x16x32_bf16 v[204:207], v[120:123], v[88:91], v[204:207]
    s_mul_i32 s50, s50, 40960
    v_mfma_f32_16x16x32_bf16 v[208:211], v[120:123], v[92:95], v[208:211]
    s_lshl_b32 s49, s49, 5
    v_mfma_f32_16x16x32_bf16 v[212:215], v[120:123], v[96:99], v[212:215]
    s_add_u32 s49, s49, s50
    v_mfma_f32_16x16x32_bf16 v[216:219], v[120:123], v[100:103], v[216:219]
    s_add_u32 s49, s49, s58
    v_mfma_f32_16x16x32_bf16 v[220:223], v[120:123], v[104:107], v[220:223]
    s_cmp_eq_u32 s48, 15
    v_mfma_f32_16x16x32_bf16 v[224:227], v[124:127], v[84:87], v[224:227]
    s_cselect_b32 s59, 0x7ff00000, s49
    v_mfma_f32_16x16x32_bf16 v[228:231], v[124:127], v[88:91], v[228:231]
    s_lshl_b32 s48, s3, 2
    v_mfma_f32_16x16x32_bf16 v[232:235], v[124:127], v[92:95], v[232:235]
    s_add_u32 s48, s48, 1
    v_mfma_f32_16x16x32_bf16 v[236:239], v[124:127], v[96:99], v[236:239]
    s_mul_i32 s49, s48, 86
    v_mfma_f32_16x16x32_bf16 v[240:243], v[124:127], v[100:103], v[240:243]
    s_lshr_b32 s49, s49, 8
    v_mfma_f32_16x16x32_bf16 v[244:247], v[124:127], v[104:107], v[244:247]
    s_mul_i32 s50, s49, 3
    s_waitcnt lgkmcnt(8)
    v_mfma_f32_16x16x32_bf16 v[128:131], v[64:67], v[40:43], v[128:131]
    s_sub_u32 s50, s48, s50
    v_mfma_f32_16x16x32_bf16 v[132:135], v[64:67], v[44:47], v[132:135]
    s_mul_i32 s50, s50, 40960
    v_mfma_f32_16x16x32_bf16 v[136:139], v[64:67], v[48:51], v[136:139]
    s_waitcnt lgkmcnt(0)
    s_barrier
    ds_read_b128 v[84:87], v5 offset:0
    s_lshl_b32 s49, s49, 5
    v_mfma_f32_16x16x32_bf16 v[140:143], v[64:67], v[52:55], v[140:143]
    ds_read_b64_tr_b16 v[108:109], v3 offset:30720
    s_add_u32 s49, s49, s50
    v_mfma_f32_16x16x32_bf16 v[144:147], v[64:67], v[56:59], v[144:147]
    ds_read_b64_tr_b16 v[110:111], v3 offset:35840
    s_add_u32 s49, s49, s58
    v_mfma_f32_16x16x32_bf16 v[148:151], v[64:67], v[60:63], v[148:151]
    ds_read_b128 v[88:91], v5 offset:1024
    s_cmp_eq_u32 s48, 15
    v_mfma_f32_16x16x32_bf16 v[152:155], v[68:71], v[40:43], v[152:155]
    ds_read_b128 v[92:95], v5 offset:2048
    s_cselect_b32 s60, 0x7ff00000, s49
    v_mfma_f32_16x16x32_bf16 v[156:159], v[68:71], v[44:47], v[156:159]
    ds_read_b128 v[96:99], v5 offset:3072
    s_lshl_b32 s48, s3, 2
    v_mfma_f32_16x16x32_bf16 v[160:163], v[68:71], v[48:51], v[160:163]
    ds_read_b128 v[100:103], v5 offset:4096
    s_add_u32 s48, s48, 2
    v_mfma_f32_16x16x32_bf16 v[164:167], v[68:71], v[52:55], v[164:167]
    ds_read_b128 v[104:107], v5 offset:5120
    s_mul_i32 s49, s48, 86
    v_mfma_f32_16x16x32_bf16 v[168:171], v[68:71], v[56:59], v[168:171]
    ds_read_b64_tr_b16 v[112:113], v4 offset:30752
    s_lshr_b32 s49, s49, 8
    v_mfma_f32_16x16x32_bf16 v[172:175], v[68:71], v[60:63], v[172:175]
    ds_read_b64_tr_b16 v[114:115], v4 offset:35872
    s_mul_i32 s50, s49, 3
    v_mfma_f32_16x16x32_bf16 v[176:179], v[72:75], v[40:43], v[176:179]
    ds_read_b64_tr_b16 v[116:117], v3 offset:30784
    s_sub_u32 s50, s48, s50
    v_mfma_f32_16x16x32_bf16 v[180:183], v[72:75], v[44:47], v[180:183]
    ds_read_b64_tr_b16 v[118:119], v3 offset:35904
    s_mul_i32 s50, s50, 40960
    v_mfma_f32_16x16x32_bf16 v[184:187], v[72:75], v[48:51], v[184:187]
    ds_read_b64_tr_b16 v[120:121], v4 offset:30816
    s_lshl_b32 s49, s49, 5
    v_mfma_f32_16x16x32_bf16 v[188:191], v[72:75], v[52:55], v[188:191]
    ds_read_b64_tr_b16 v[122:123], v4 offset:35936
    s_add_u32 s49, s49, s50
    v_mfma_f32_16x16x32_bf16 v[192:195], v[72:75], v[56:59], v[192:195]
    ds_read_b64_tr_b16 v[124:125], v3 offset:30848
    s_add_u32 s49, s49, s58
    v_mfma_f32_16x16x32_bf16 v[196:199], v[72:75], v[60:63], v[196:199]
    ds_read_b64_tr_b16 v[126:127], v3 offset:35968
    s_cmp_eq_u32 s48, 15
    v_mfma_f32_16x16x32_bf16 v[200:203], v[76:79], v[40:43], v[200:203]
    s_cselect_b32 s56, 0x7ff00000, s49
    v_mfma_f32_16x16x32_bf16 v[204:207], v[76:79], v[44:47], v[204:207]
    s_lshl_b32 s48, s3, 2
    v_mfma_f32_16x16x32_bf16 v[208:211], v[76:79], v[48:51], v[208:211]
    s_add_u32 s48, s48, 3
    v_mfma_f32_16x16x32_bf16 v[212:215], v[76:79], v[52:55], v[212:215]
    s_mul_i32 s49, s48, 86
    v_mfma_f32_16x16x32_bf16 v[216:219], v[76:79], v[56:59], v[216:219]
    s_lshr_b32 s49, s49, 8
    v_mfma_f32_16x16x32_bf16 v[220:223], v[76:79], v[60:63], v[220:223]
    s_mul_i32 s50, s49, 3
    v_mfma_f32_16x16x32_bf16 v[224:227], v[80:83], v[40:43], v[224:227]
    s_sub_u32 s50, s48, s50
    v_mfma_f32_16x16x32_bf16 v[228:231], v[80:83], v[44:47], v[228:231]
    s_mul_i32 s50, s50, 40960
    v_mfma_f32_16x16x32_bf16 v[232:235], v[80:83], v[48:51], v[232:235]
    s_lshl_b32 s49, s49, 5
    v_mfma_f32_16x16x32_bf16 v[236:239], v[80:83], v[52:55], v[236:239]
    s_add_u32 s49, s49, s50
    v_mfma_f32_16x16x32_bf16 v[240:243], v[80:83], v[56:59], v[240:243]
    s_add_u32 s49, s49, s58
    v_mfma_f32_16x16x32_bf16 v[244:247], v[80:83], v[60:63], v[244:247]
    s_cmp_eq_u32 s48, 15
    s_waitcnt lgkmcnt(8)
    v_mfma_f32_16x16x32_bf16 v[128:131], v[108:111], v[84:87], v[128:131]
    s_cselect_b32 s97, 0x7ff00000, s49
    v_mfma_f32_16x16x32_bf16 v[132:135], v[108:111], v[88:91], v[132:135]
    v_mfma_f32_16x16x32_bf16 v[136:139], v[108:111], v[92:95], v[136:139]
    ds_read_b128 v[40:43], v5 offset:12288
    v_mfma_f32_16x16x32_bf16 v[140:143], v[108:111], v[96:99], v[140:143]
    ds_read_b64_tr_b16 v[64:65], v3 offset:40960
    v_mfma_f32_16x16x32_bf16 v[144:147], v[108:111], v[100:103], v[144:147]
    ds_read_b64_tr_b16 v[66:67], v3 offset:46080
    v_mfma_f32_16x16x32_bf16 v[148:151], v[108:111], v[104:107], v[148:151]
    ds_read_b128 v[44:47], v5 offset:13312
    s_waitcnt lgkmcnt(10)
    v_mfma_f32_16x16x32_bf16 v[152:155], v[112:115], v[84:87], v[152:155]
    ds_read_b128 v[48:51], v5 offset:14336
    v_mfma_f32_16x16x32_bf16 v[156:159], v[112:115], v[88:91], v[156:159]
    ds_read_b128 v[52:55], v5 offset:15360
    v_mfma_f32_16x16x32_bf16 v[160:163], v[112:115], v[92:95], v[160:163]
    ds_read_b128 v[56:59], v5 offset:16384
    v_mfma_f32_16x16x32_bf16 v[164:167], v[112:115], v[96:99], v[164:167]
    ds_read_b128 v[60:63], v5 offset:17408
    v_mfma_f32_16x16x32_bf16 v[168:171], v[112:115], v[100:103], v[168:171]
    ds_read_b64_tr_b16 v[68:69], v4 offset:40992
    v_mfma_f32_16x16x32_bf16 v[172:175], v[112:115], v[104:107], v[172:175]
    ds_read_b64_tr_b16 v[70:71], v4 offset:46112
    s_waitcnt lgkmcnt(14)
    v_mfma_f32_16x16x32_bf16 v[176:179], v[116:119], v[84:87], v[176:179]
    ds_read_b64_tr_b16 v[72:73], v3 offset:41024
    v_mfma_f32_16x16x32_bf16 v[180:183], v[116:119], v[88:91], v[180:183]
    ds_read_b64_tr_b16 v[74:75], v3 offset:46144
    v_mfma_f32_16x16x32_bf16 v[184:187], v[116:119], v[92:95], v[184:187]
    ds_read_b64_tr_b16 v[76:77], v4 offset:41056
    v_mfma_f32_16x16x32_bf16 v[188:191], v[116:119], v[96:99], v[188:191]
    ds_read_b64_tr_b16 v[78:79], v4 offset:46176
    v_mfma_f32_16x16x32_bf16 v[192:195], v[116:119], v[100:103], v[192:195]
    ds_read_b64_tr_b16 v[80:81], v3 offset:41088
    v_mfma_f32_16x16x32_bf16 v[196:199], v[116:119], v[104:107], v[196:199]
    ds_read_b64_tr_b16 v[82:83], v3 offset:46208
    s_waitcnt lgkmcnt(15)
    v_mfma_f32_16x16x32_bf16 v[200:203], v[120:123], v[84:87], v[200:203]
    v_mfma_f32_16x16x32_bf16 v[204:207], v[120:123], v[88:91], v[204:207]
    v_mfma_f32_16x16x32_bf16 v[208:211], v[120:123], v[92:95], v[208:211]
    v_mfma_f32_16x16x32_bf16 v[212:215], v[120:123], v[96:99], v[212:215]
    v_mfma_f32_16x16x32_bf16 v[216:219], v[120:123], v[100:103], v[216:219]
    v_mfma_f32_16x16x32_bf16 v[220:223], v[120:123], v[104:107], v[220:223]
    v_mfma_f32_16x16x32_bf16 v[224:227], v[124:127], v[84:87], v[224:227]
    v_mfma_f32_16x16x32_bf16 v[228:231], v[124:127], v[88:91], v[228:231]
    v_mfma_f32_16x16x32_bf16 v[232:235], v[124:127], v[92:95], v[232:235]
    v_mfma_f32_16x16x32_bf16 v[236:239], v[124:127], v[96:99], v[236:239]
    v_mfma_f32_16x16x32_bf16 v[240:243], v[124:127], v[100:103], v[240:243]
    v_mfma_f32_16x16x32_bf16 v[244:247], v[124:127], v[104:107], v[244:247]
    s_waitcnt lgkmcnt(8)
    v_mfma_f32_16x16x32_bf16 v[128:131], v[64:67], v[40:43], v[128:131]
    v_mfma_f32_16x16x32_bf16 v[132:135], v[64:67], v[44:47], v[132:135]
    v_mfma_f32_16x16x32_bf16 v[136:139], v[64:67], v[48:51], v[136:139]
    ds_read_b128 v[84:87], v5 offset:24576
    v_mfma_f32_16x16x32_bf16 v[140:143], v[64:67], v[52:55], v[140:143]
    ds_read_b64_tr_b16 v[108:109], v3 offset:51200
    v_mfma_f32_16x16x32_bf16 v[144:147], v[64:67], v[56:59], v[144:147]
    ds_read_b64_tr_b16 v[110:111], v3 offset:56320
    v_mfma_f32_16x16x32_bf16 v[148:151], v[64:67], v[60:63], v[148:151]
    ds_read_b128 v[88:91], v5 offset:25600
    s_waitcnt lgkmcnt(10)
    v_mfma_f32_16x16x32_bf16 v[152:155], v[68:71], v[40:43], v[152:155]
    ds_read_b128 v[92:95], v5 offset:26624
    v_mfma_f32_16x16x32_bf16 v[156:159], v[68:71], v[44:47], v[156:159]
    ds_read_b128 v[96:99], v5 offset:27648
    v_mfma_f32_16x16x32_bf16 v[160:163], v[68:71], v[48:51], v[160:163]
    ds_read_b128 v[100:103], v5 offset:28672
    v_mfma_f32_16x16x32_bf16 v[164:167], v[68:71], v[52:55], v[164:167]
    ds_read_b128 v[104:107], v5 offset:29696
    v_mfma_f32_16x16x32_bf16 v[168:171], v[68:71], v[56:59], v[168:171]
    ds_read_b64_tr_b16 v[112:113], v4 offset:51232
    v_mfma_f32_16x16x32_bf16 v[172:175], v[68:71], v[60:63], v[172:175]
    ds_read_b64_tr_b16 v[114:115], v4 offset:56352
    s_waitcnt lgkmcnt(14)
    v_mfma_f32_16x16x32_bf16 v[176:179], v[72:75], v[40:43], v[176:179]
    ds_read_b64_tr_b16 v[116:117], v3 offset:51264
    v_mfma_f32_16x16x32_bf16 v[180:183], v[72:75], v[44:47], v[180:183]
    ds_read_b64_tr_b16 v[118:119], v3 offset:56384
    v_mfma_f32_16x16x32_bf16 v[184:187], v[72:75], v[48:51], v[184:187]
    ds_read_b64_tr_b16 v[120:121], v4 offset:51296
    v_mfma_f32_16x16x32_bf16 v[188:191], v[72:75], v[52:55], v[188:191]
    ds_read_b64_tr_b16 v[122:123], v4 offset:56416
    v_mfma_f32_16x16x32_bf16 v[192:195], v[72:75], v[56:59], v[192:195]
    ds_read_b64_tr_b16 v[124:125], v3 offset:51328
    v_mfma_f32_16x16x32_bf16 v[196:199], v[72:75], v[60:63], v[196:199]
    ds_read_b64_tr_b16 v[126:127], v3 offset:56448
    s_waitcnt lgkmcnt(15)
    v_mfma_f32_16x16x32_bf16 v[200:203], v[76:79], v[40:43], v[200:203]
    v_mfma_f32_16x16x32_bf16 v[204:207], v[76:79], v[44:47], v[204:207]
    v_mfma_f32_16x16x32_bf16 v[208:211], v[76:79], v[48:51], v[208:211]
    v_mfma_f32_16x16x32_bf16 v[212:215], v[76:79], v[52:55], v[212:215]
    v_mfma_f32_16x16x32_bf16 v[216:219], v[76:79], v[56:59], v[216:219]
    v_mfma_f32_16x16x32_bf16 v[220:223], v[76:79], v[60:63], v[220:223]
    v_mfma_f32_16x16x32_bf16 v[224:227], v[80:83], v[40:43], v[224:227]
    v_mfma_f32_16x16x32_bf16 v[228:231], v[80:83], v[44:47], v[228:231]
    v_mfma_f32_16x16x32_bf16 v[232:235], v[80:83], v[48:51], v[232:235]
    v_mfma_f32_16x16x32_bf16 v[236:239], v[80:83], v[52:55], v[236:239]
    v_mfma_f32_16x16x32_bf16 v[240:243], v[80:83], v[56:59], v[240:243]
    v_mfma_f32_16x16x32_bf16 v[244:247], v[80:83], v[60:63], v[244:247]
    s_waitcnt lgkmcnt(8)
    v_mfma_f32_16x16x32_bf16 v[128:131], v[108:111], v[84:87], v[128:131]
    v_mfma_f32_16x16x32_bf16 v[132:135], v[108:111], v[88:91], v[132:135]
    v_mfma_f32_16x16x32_bf16 v[136:139], v[108:111], v[92:95], v[136:139]
    s_waitcnt lgkmcnt(0)
    s_barrier
    s_barrier
    ds_read_b128 v[40:43], v2 offset:0
    v_mfma_f32_16x16x32_bf16 v[140:143], v[108:111], v[96:99], v[140:143]
    ds_read_b64_tr_b16 v[64:65], v3 offset:0
    v_mfma_f32_16x16x32_bf16 v[144:147], v[108:111], v[100:103], v[144:147]
    ds_read_b64_tr_b16 v[66:67], v3 offset:5120
    v_mfma_f32_16x16x32_bf16 v[148:151], v[108:111], v[104:107], v[148:151]
    ds_read_b128 v[44:47], v2 offset:1024
    v_mfma_f32_16x16x32_bf16 v[152:155], v[112:115], v[84:87], v[152:155]
    ds_read_b128 v[48:51], v2 offset:2048
    v_mfma_f32_16x16x32_bf16 v[156:159], v[112:115], v[88:91], v[156:159]
    ds_read_b128 v[52:55], v2 offset:3072
    v_mfma_f32_16x16x32_bf16 v[160:163], v[112:115], v[92:95], v[160:163]
    ds_read_b128 v[56:59], v2 offset:4096
    v_mfma_f32_16x16x32_bf16 v[164:167], v[112:115], v[96:99], v[164:167]
    ds_read_b128 v[60:63], v2 offset:5120
    v_mfma_f32_16x16x32_bf16 v[168:171], v[112:115], v[100:103], v[168:171]
    ds_read_b64_tr_b16 v[68:69], v4 offset:32
    v_mfma_f32_16x16x32_bf16 v[172:175], v[112:115], v[104:107], v[172:175]
    ds_read_b64_tr_b16 v[70:71], v4 offset:5152
    v_mfma_f32_16x16x32_bf16 v[176:179], v[116:119], v[84:87], v[176:179]
    ds_read_b64_tr_b16 v[72:73], v3 offset:64
    v_mfma_f32_16x16x32_bf16 v[180:183], v[116:119], v[88:91], v[180:183]
    ds_read_b64_tr_b16 v[74:75], v3 offset:5184
    v_mfma_f32_16x16x32_bf16 v[184:187], v[116:119], v[92:95], v[184:187]
    ds_read_b64_tr_b16 v[76:77], v4 offset:96
    v_mfma_f32_16x16x32_bf16 v[188:191], v[116:119], v[96:99], v[188:191]
    ds_read_b64_tr_b16 v[78:79], v4 offset:5216
    v_mfma_f32_16x16x32_bf16 v[192:195], v[116:119], v[100:103], v[192:195]
    ds_read_b64_tr_b16 v[80:81], v3 offset:128
    v_mfma_f32_16x16x32_bf16 v[196:199], v[116:119], v[104:107], v[196:199]
    ds_read_b64_tr_b16 v[82:83], v3 offset:5248
    v_mfma_f32_16x16x32_bf16 v[200:203], v[120:123], v[84:87], v[200:203]
    v_mfma_f32_16x16x32_bf16 v[204:207], v[120:123], v[88:91], v[204:207]
    v_mfma_f32_16x16x32_bf16 v[208:211], v[120:123], v[92:95], v[208:211]
    v_mfma_f32_16x16x32_bf16 v[212:215], v[120:123], v[96:99], v[212:215]
    v_mfma_f32_16x16x32_bf16 v[216:219], v[120:123], v[100:103], v[216:219]
    v_mfma_f32_16x16x32_bf16 v[220:223], v[120:123], v[104:107], v[220:223]
    v_mfma_f32_16x16x32_bf16 v[224:227], v[124:127], v[84:87], v[224:227]
    v_mfma_f32_16x16x32_bf16 v[228:231], v[124:127], v[88:91], v[228:231]
    v_mfma_f32_16x16x32_bf16 v[232:235], v[124:127], v[92:95], v[232:235]
    v_mfma_f32_16x16x32_bf16 v[236:239], v[124:127], v[96:99], v[236:239]
    v_mfma_f32_16x16x32_bf16 v[240:243], v[124:127], v[100:103], v[240:243]
    v_mfma_f32_16x16x32_bf16 v[244:247], v[124:127], v[104:107], v[244:247]
p2loop_68:
    s_add_u32 s57, s57, 1
    s_waitcnt lgkmcnt(8)
    v_mfma_f32_16x16x32_bf16 v[128:131], v[64:67], v[40:43], v[128:131]
    v_mfma_f32_16x16x32_bf16 v[132:135], v[64:67], v[44:47], v[132:135]
    v_mfma_f32_16x16x32_bf16 v[136:139], v[64:67], v[48:51], v[136:139]
    s_waitcnt lgkmcnt(0)
    s_barrier
    ds_read_b128 v[84:87], v2 offset:12288
    v_mfma_f32_16x16x32_bf16 v[140:143], v[64:67], v[52:55], v[140:143]
    ds_read_b64_tr_b16 v[108:109], v3 offset:10240
    v_mfma_f32_16x16x32_bf16 v[144:147], v[64:67], v[56:59], v[144:147]
    ds_read_b64_tr_b16 v[110:111], v3 offset:15360
    v_mfma_f32_16x16x32_bf16 v[148:151], v[64:67], v[60:63], v[148:151]
    ds_read_b128 v[88:91], v2 offset:13312
    v_mfma_f32_16x16x32_bf16 v[152:155], v[68:71], v[40:43], v[152:155]
    ds_read_b128 v[92:95], v2 offset:14336
    v_mfma_f32_16x16x32_bf16 v[156:159], v[68:71], v[44:47], v[156:159]
    ds_read_b128 v[96:99], v2 offset:15360
    v_mfma_f32_16x16x32_bf16 v[160:163], v[68:71], v[48:51], v[160:163]
    ds_read_b128 v[100:103], v2 offset:16384
    v_mfma_f32_16x16x32_bf16 v[164:167], v[68:71], v[52:55], v[164:167]
    ds_read_b128 v[104:107], v2 offset:17408
    v_mfma_f32_16x16x32_bf16 v[168:171], v[68:71], v[56:59], v[168:171]
    ds_read_b64_tr_b16 v[112:113], v4 offset:10272
    v_mfma_f32_16x16x32_bf16 v[172:175], v[68:71], v[60:63], v[172:175]
    ds_read_b64_tr_b16 v[114:115], v4 offset:15392
    v_mfma_f32_16x16x32_bf16 v[176:179], v[72:75], v[40:43], v[176:179]
    ds_read_b64_tr_b16 v[116:117], v3 offset:10304
    v_mfma_f32_16x16x32_bf16 v[180:183], v[72:75], v[44:47], v[180:183]
    ds_read_b64_tr_b16 v[118:119], v3 offset:15424
    v_mfma_f32_16x16x32_bf16 v[184:187], v[72:75], v[48:51], v[184:187]
    ds_read_b64_tr_b16 v[120:121], v4 offset:10336
    v_mfma_f32_16x16x32_bf16 v[188:191], v[72:75], v[52:55], v[188:191]
    ds_read_b64_tr_b16 v[122:123], v4 offset:15456
    v_mfma_f32_16x16x32_bf16 v[192:195], v[72:75], v[56:59], v[192:195]
    ds_read_b64_tr_b16 v[124:125], v3 offset:10368
    v_mfma_f32_16x16x32_bf16 v[196:199], v[72:75], v[60:63], v[196:199]
    ds_read_b64_tr_b16 v[126:127], v3 offset:15488
    v_mfma_f32_16x16x32_bf16 v[200:203], v[76:79], v[40:43], v[200:203]
    v_mfma_f32_16x16x32_bf16 v[204:207], v[76:79], v[44:47], v[204:207]
    v_mfma_f32_16x16x32_bf16 v[208:211], v[76:79], v[48:51], v[208:211]
    v_mfma_f32_16x16x32_bf16 v[212:215], v[76:79], v[52:55], v[212:215]
    v_mfma_f32_16x16x32_bf16 v[216:219], v[76:79], v[56:59], v[216:219]
    v_mfma_f32_16x16x32_bf16 v[220:223], v[76:79], v[60:63], v[220:223]
    v_mfma_f32_16x16x32_bf16 v[224:227], v[80:83], v[40:43], v[224:227]
    v_mfma_f32_16x16x32_bf16 v[228:231], v[80:83], v[44:47], v[228:231]
    v_mfma_f32_16x16x32_bf16 v[232:235], v[80:83], v[48:51], v[232:235]
    v_mfma_f32_16x16x32_bf16 v[236:239], v[80:83], v[52:55], v[236:239]
    v_mfma_f32_16x16x32_bf16 v[240:243], v[80:83], v[56:59], v[240:243]
    v_mfma_f32_16x16x32_bf16 v[244:247], v[80:83], v[60:63], v[244:247]
    s_waitcnt lgkmcnt(8)
    v_mfma_f32_16x16x32_bf16 v[128:131], v[108:111], v[84:87], v[128:131]
    v_mfma_f32_16x16x32_bf16 v[132:135], v[108:111], v[88:91], v[132:135]
    v_mfma_f32_16x16x32_bf16 v[136:139], v[108:111], v[92:95], v[136:139]
    s_waitcnt lgkmcnt(0)
    s_barrier
    ds_read_b128 v[40:43], v2 offset:24576
    v_mfma_f32_16x16x32_bf16 v[140:143], v[108:111], v[96:99], v[140:143]
    ds_read_b64_tr_b16 v[64:65], v3 offset:20480
    v_mfma_f32_16x16x32_bf16 v[144:147], v[108:111], v[100:103], v[144:147]
    ds_read_b64_tr_b16 v[66:67], v3 offset:25600
    v_mfma_f32_16x16x32_bf16 v[148:151], v[108:111], v[104:107], v[148:151]
    ds_read_b128 v[44:47], v2 offset:25600
    v_mfma_f32_16x16x32_bf16 v[152:155], v[112:115], v[84:87], v[152:155]
    ds_read_b128 v[48:51], v2 offset:26624
    v_mfma_f32_16x16x32_bf16 v[156:159], v[112:115], v[88:91], v[156:159]
    ds_read_b128 v[52:55], v2 offset:27648
    v_mfma_f32_16x16x32_bf16 v[160:163], v[112:115], v[92:95], v[160:163]
    ds_read_b128 v[56:59], v2 offset:28672
    v_mfma_f32_16x16x32_bf16 v[164:167], v[112:115], v[96:99], v[164:167]
    ds_read_b128 v[60:63], v2 offset:29696
    v_mfma_f32_16x16x32_bf16 v[168:171], v[112:115], v[100:103], v[168:171]
    ds_read_b64_tr_b16 v[68:69], v4 offset:20512
    v_mfma_f32_16x16x32_bf16 v[172:175], v[112:115], v[104:107], v[172:175]
    ds_read_b64_tr_b16 v[70:71], v4 offset:25632
    v_mfma_f32_16x16x32_bf16 v[176:179], v[116:119], v[84:87], v[176:179]
    ds_read_b64_tr_b16 v[72:73], v3 offset:20544
    v_mfma_f32_16x16x32_bf16 v[180:183], v[116:119], v[88:91], v[180:183]
    ds_read_b64_tr_b16 v[74:75], v3 offset:25664
    v_mfma_f32_16x16x32_bf16 v[184:187], v[116:119], v[92:95], v[184:187]
    ds_read_b64_tr_b16 v[76:77], v4 offset:20576
    v_mfma_f32_16x16x32_bf16 v[188:191], v[116:119], v[96:99], v[188:191]
    ds_read_b64_tr_b16 v[78:79], v4 offset:25696
    v_mfma_f32_16x16x32_bf16 v[192:195], v[116:119], v[100:103], v[192:195]
    ds_read_b64_tr_b16 v[80:81], v3 offset:20608
    v_mfma_f32_16x16x32_bf16 v[196:199], v[116:119], v[104:107], v[196:199]
    ds_read_b64_tr_b16 v[82:83], v3 offset:25728
    v_mfma_f32_16x16x32_bf16 v[200:203], v[120:123], v[84:87], v[200:203]
    v_mfma_f32_16x16x32_bf16 v[204:207], v[120:123], v[88:91], v[204:207]
    v_mfma_f32_16x16x32_bf16 v[208:211], v[120:123], v[92:95], v[208:211]
    v_mfma_f32_16x16x32_bf16 v[212:215], v[120:123], v[96:99], v[212:215]
    v_mfma_f32_16x16x32_bf16 v[216:219], v[120:123], v[100:103], v[216:219]
    v_mfma_f32_16x16x32_bf16 v[220:223], v[120:123], v[104:107], v[220:223]
    v_mfma_f32_16x16x32_bf16 v[224:227], v[124:127], v[84:87], v[224:227]
    v_mfma_f32_16x16x32_bf16 v[228:231], v[124:127], v[88:91], v[228:231]
    v_mfma_f32_16x16x32_bf16 v[232:235], v[124:127], v[92:95], v[232:235]
    v_mfma_f32_16x16x32_bf16 v[236:239], v[124:127], v[96:99], v[236:239]
    v_mfma_f32_16x16x32_bf16 v[240:243], v[124:127], v[100:103], v[240:243]
    v_mfma_f32_16x16x32_bf16 v[244:247], v[124:127], v[104:107], v[244:247]
    s_waitcnt lgkmcnt(8)
    v_mfma_f32_16x16x32_bf16 v[128:131], v[64:67], v[40:43], v[128:131]
    v_mfma_f32_16x16x32_bf16 v[132:135], v[64:67], v[44:47], v[132:135]
    v_mfma_f32_16x16x32_bf16 v[136:139], v[64:67], v[48:51], v[136:139]
    s_waitcnt lgkmcnt(0)
    s_barrier
    ds_read_b128 v[84:87], v5 offset:0
    v_mfma_f32_16x16x32_bf16 v[140:143], v[64:67], v[52:55], v[140:143]
    ds_read_b64_tr_b16 v[108:109], v3 offset:30720
    v_mfma_f32_16x16x32_bf16 v[144:147], v[64:67], v[56:59], v[144:147]
    ds_read_b64_tr_b16 v[110:111], v3 offset:35840
    v_mfma_f32_16x16x32_bf16 v[148:151], v[64:67], v[60:63], v[148:151]
    ds_read_b128 v[88:91], v5 offset:1024
    v_mfma_f32_16x16x32_bf16 v[152:155], v[68:71], v[40:43], v[152:155]
    ds_read_b128 v[92:95], v5 offset:2048
    v_mfma_f32_16x16x32_bf16 v[156:159], v[68:71], v[44:47], v[156:159]
    ds_read_b128 v[96:99], v5 offset:3072
    v_mfma_f32_16x16x32_bf16 v[160:163], v[68:71], v[48:51], v[160:163]
    ds_read_b128 v[100:103], v5 offset:4096
    v_mfma_f32_16x16x32_bf16 v[164:167], v[68:71], v[52:55], v[164:167]
    ds_read_b128 v[104:107], v5 offset:5120
    v_mfma_f32_16x16x32_bf16 v[168:171], v[68:71], v[56:59], v[168:171]
    ds_read_b64_tr_b16 v[112:113], v4 offset:30752
    v_mfma_f32_16x16x32_bf16 v[172:175], v[68:71], v[60:63], v[172:175]
    ds_read_b64_tr_b16 v[114:115], v4 offset:35872
    v_mfma_f32_16x16x32_bf16 v[176:179], v[72:75], v[40:43], v[176:179]
    ds_read_b64_tr_b16 v[116:117], v3 offset:30784
    v_mfma_f32_16x16x32_bf16 v[180:183], v[72:75], v[44:47], v[180:183]
    ds_read_b64_tr_b16 v[118:119], v3 offset:35904
    v_mfma_f32_16x16x32_bf16 v[184:187], v[72:75], v[48:51], v[184:187]
    ds_read_b64_tr_b16 v[120:121], v4 offset:30816
    v_mfma_f32_16x16x32_bf16 v[188:191], v[72:75], v[52:55], v[188:191]
    ds_read_b64_tr_b16 v[122:123], v4 offset:35936
    v_mfma_f32_16x16x32_bf16 v[192:195], v[72:75], v[56:59], v[192:195]
    ds_read_b64_tr_b16 v[124:125], v3 offset:30848
    v_mfma_f32_16x16x32_bf16 v[196:199], v[72:75], v[60:63], v[196:199]
    ds_read_b64_tr_b16 v[126:127], v3 offset:35968
    v_mfma_f32_16x16x32_bf16 v[200:203], v[76:79], v[40:43], v[200:203]
    v_mfma_f32_16x16x32_bf16 v[204:207], v[76:79], v[44:47], v[204:207]
    v_mfma_f32_16x16x32_bf16 v[208:211], v[76:79], v[48:51], v[208:211]
    v_mfma_f32_16x16x32_bf16 v[212:215], v[76:79], v[52:55], v[212:215]
    v_mfma_f32_16x16x32_bf16 v[216:219], v[76:79], v[56:59], v[216:219]
    v_mfma_f32_16x16x32_bf16 v[220:223], v[76:79], v[60:63], v[220:223]
    v_mfma_f32_16x16x32_bf16 v[224:227], v[80:83], v[40:43], v[224:227]
    v_mfma_f32_16x16x32_bf16 v[228:231], v[80:83], v[44:47], v[228:231]
    v_mfma_f32_16x16x32_bf16 v[232:235], v[80:83], v[48:51], v[232:235]
    v_mfma_f32_16x16x32_bf16 v[236:239], v[80:83], v[52:55], v[236:239]
    v_mfma_f32_16x16x32_bf16 v[240:243], v[80:83], v[56:59], v[240:243]
    v_mfma_f32_16x16x32_bf16 v[244:247], v[80:83], v[60:63], v[244:247]
    s_waitcnt lgkmcnt(8)
    v_mfma_f32_16x16x32_bf16 v[128:131], v[108:111], v[84:87], v[128:131]
    v_mfma_f32_16x16x32_bf16 v[132:135], v[108:111], v[88:91], v[132:135]
    v_mfma_f32_16x16x32_bf16 v[136:139], v[108:111], v[92:95], v[136:139]
    s_waitcnt lgkmcnt(0)
    s_barrier
    ds_read_b128 v[40:43], v5 offset:12288
    v_mfma_f32_16x16x32_bf16 v[140:143], v[108:111], v[96:99], v[140:143]
    ds_read_b64_tr_b16 v[64:65], v3 offset:40960
    v_mfma_f32_16x16x32_bf16 v[144:147], v[108:111], v[100:103], v[144:147]
    ds_read_b64_tr_b16 v[66:67], v3 offset:46080
    v_mfma_f32_16x16x32_bf16 v[148:151], v[108:111], v[104:107], v[148:151]
    ds_read_b128 v[44:47], v5 offset:13312
    v_mfma_f32_16x16x32_bf16 v[152:155], v[112:115], v[84:87], v[152:155]
    ds_read_b128 v[48:51], v5 offset:14336
    v_mfma_f32_16x16x32_bf16 v[156:159], v[112:115], v[88:91], v[156:159]
    ds_read_b128 v[52:55], v5 offset:15360
    v_mfma_f32_16x16x32_bf16 v[160:163], v[112:115], v[92:95], v[160:163]
    ds_read_b128 v[56:59], v5 offset:16384
    v_mfma_f32_16x16x32_bf16 v[164:167], v[112:115], v[96:99], v[164:167]
    ds_read_b128 v[60:63], v5 offset:17408
    v_mfma_f32_16x16x32_bf16 v[168:171], v[112:115], v[100:103], v[168:171]
    ds_read_b64_tr_b16 v[68:69], v4 offset:40992
    v_mfma_f32_16x16x32_bf16 v[172:175], v[112:115], v[104:107], v[172:175]
    ds_read_b64_tr_b16 v[70:71], v4 offset:46112
    v_mfma_f32_16x16x32_bf16 v[176:179], v[116:119], v[84:87], v[176:179]
    ds_read_b64_tr_b16 v[72:73], v3 offset:41024
    v_mfma_f32_16x16x32_bf16 v[180:183], v[116:119], v[88:91], v[180:183]
    ds_read_b64_tr_b16 v[74:75], v3 offset:46144
    v_mfma_f32_16x16x32_bf16 v[184:187], v[116:119], v[92:95], v[184:187]
    ds_read_b64_tr_b16 v[76:77], v4 offset:41056
    v_mfma_f32_16x16x32_bf16 v[188:191], v[116:119], v[96:99], v[188:191]
    ds_read_b64_tr_b16 v[78:79], v4 offset:46176
    v_mfma_f32_16x16x32_bf16 v[192:195], v[116:119], v[100:103], v[192:195]
    ds_read_b64_tr_b16 v[80:81], v3 offset:41088
    v_mfma_f32_16x16x32_bf16 v[196:199], v[116:119], v[104:107], v[196:199]
    ds_read_b64_tr_b16 v[82:83], v3 offset:46208
    v_mfma_f32_16x16x32_bf16 v[200:203], v[120:123], v[84:87], v[200:203]
    v_mfma_f32_16x16x32_bf16 v[204:207], v[120:123], v[88:91], v[204:207]
    v_mfma_f32_16x16x32_bf16 v[208:211], v[120:123], v[92:95], v[208:211]
    v_mfma_f32_16x16x32_bf16 v[212:215], v[120:123], v[96:99], v[212:215]
    v_mfma_f32_16x16x32_bf16 v[216:219], v[120:123], v[100:103], v[216:219]
    v_mfma_f32_16x16x32_bf16 v[220:223], v[120:123], v[104:107], v[220:223]
    v_mfma_f32_16x16x32_bf16 v[224:227], v[124:127], v[84:87], v[224:227]
    v_mfma_f32_16x16x32_bf16 v[228:231], v[124:127], v[88:91], v[228:231]
    v_mfma_f32_16x16x32_bf16 v[232:235], v[124:127], v[92:95], v[232:235]
    v_mfma_f32_16x16x32_bf16 v[236:239], v[124:127], v[96:99], v[236:239]
    v_mfma_f32_16x16x32_bf16 v[240:243], v[124:127], v[100:103], v[240:243]
    v_mfma_f32_16x16x32_bf16 v[244:247], v[124:127], v[104:107], v[244:247]
    s_waitcnt lgkmcnt(8)
    v_mfma_f32_16x16x32_bf16 v[128:131], v[64:67], v[40:43], v[128:131]
    v_mfma_f32_16x16x32_bf16 v[132:135], v[64:67], v[44:47], v[132:135]
    v_mfma_f32_16x16x32_bf16 v[136:139], v[64:67], v[48:51], v[136:139]
    s_waitcnt lgkmcnt(0)
    s_barrier
    ds_read_b128 v[84:87], v5 offset:24576
    v_mfma_f32_16x16x32_bf16 v[140:143], v[64:67], v[52:55], v[140:143]
    ds_read_b64_tr_b16 v[108:109], v3 offset:51200
    v_mfma_f32_16x16x32_bf16 v[144:147], v[64:67], v[56:59], v[144:147]
    ds_read_b64_tr_b16 v[110:111], v3 offset:56320
    v_mfma_f32_16x16x32_bf16 v[148:151], v[64:67], v[60:63], v[148:151]
    ds_read_b128 v[88:91], v5 offset:25600
    v_mfma_f32_16x16x32_bf16 v[152:155], v[68:71], v[40:43], v[152:155]
    ds_read_b128 v[92:95], v5 offset:26624
    v_mfma_f32_16x16x32_bf16 v[156:159], v[68:71], v[44:47], v[156:159]
    ds_read_b128 v[96:99], v5 offset:27648
    v_mfma_f32_16x16x32_bf16 v[160:163], v[68:71], v[48:51], v[160:163]
    ds_read_b128 v[100:103], v5 offset:28672
    v_mfma_f32_16x16x32_bf16 v[164:167], v[68:71], v[52:55], v[164:167]
    ds_read_b128 v[104:107], v5 offset:29696
    v_mfma_f32_16x16x32_bf16 v[168:171], v[68:71], v[56:59], v[168:171]
    ds_read_b64_tr_b16 v[112:113], v4 offset:51232
    v_mfma_f32_16x16x32_bf16 v[172:175], v[68:71], v[60:63], v[172:175]
    ds_read_b64_tr_b16 v[114:115], v4 offset:56352
    v_mfma_f32_16x16x32_bf16 v[176:179], v[72:75], v[40:43], v[176:179]
    ds_read_b64_tr_b16 v[116:117], v3 offset:51264
    v_mfma_f32_16x16x32_bf16 v[180:183], v[72:75], v[44:47], v[180:183]
    ds_read_b64_tr_b16 v[118:119], v3 offset:56384
    v_mfma_f32_16x16x32_bf16 v[184:187], v[72:75], v[48:51], v[184:187]
    ds_read_b64_tr_b16 v[120:121], v4 offset:51296
    v_mfma_f32_16x16x32_bf16 v[188:191], v[72:75], v[52:55], v[188:191]
    ds_read_b64_tr_b16 v[122:123], v4 offset:56416
    v_mfma_f32_16x16x32_bf16 v[192:195], v[72:75], v[56:59], v[192:195]
    ds_read_b64_tr_b16 v[124:125], v3 offset:51328
    v_mfma_f32_16x16x32_bf16 v[196:199], v[72:75], v[60:63], v[196:199]
    ds_read_b64_tr_b16 v[126:127], v3 offset:56448
    v_mfma_f32_16x16x32_bf16 v[200:203], v[76:79], v[40:43], v[200:203]
    v_mfma_f32_16x16x32_bf16 v[204:207], v[76:79], v[44:47], v[204:207]
    v_mfma_f32_16x16x32_bf16 v[208:211], v[76:79], v[48:51], v[208:211]
    v_mfma_f32_16x16x32_bf16 v[212:215], v[76:79], v[52:55], v[212:215]
    v_mfma_f32_16x16x32_bf16 v[216:219], v[76:79], v[56:59], v[216:219]
    v_mfma_f32_16x16x32_bf16 v[220:223], v[76:79], v[60:63], v[220:223]
    v_mfma_f32_16x16x32_bf16 v[224:227], v[80:83], v[40:43], v[224:227]
    v_mfma_f32_16x16x32_bf16 v[228:231], v[80:83], v[44:47], v[228:231]
    v_mfma_f32_16x16x32_bf16 v[232:235], v[80:83], v[48:51], v[232:235]
    v_mfma_f32_16x16x32_bf16 v[236:239], v[80:83], v[52:55], v[236:239]
    v_mfma_f32_16x16x32_bf16 v[240:243], v[80:83], v[56:59], v[240:243]
    v_mfma_f32_16x16x32_bf16 v[244:247], v[80:83], v[60:63], v[244:247]
    s_cmp_ge_u32 s57, 3
    s_cbranch_scc1 p2out_69
    s_waitcnt lgkmcnt(8)
    v_mfma_f32_16x16x32_bf16 v[128:131], v[108:111], v[84:87], v[128:131]
    v_mfma_f32_16x16x32_bf16 v[132:135], v[108:111], v[88:91], v[132:135]
    v_mfma_f32_16x16x32_bf16 v[136:139], v[108:111], v[92:95], v[136:139]
    s_waitcnt lgkmcnt(0)
    s_barrier
    ds_read_b128 v[40:43], v2 offset:0
    v_mfma_f32_16x16x32_bf16 v[140:143], v[108:111], v[96:99], v[140:143]
    ds_read_b64_tr_b16 v[64:65], v3 offset:0
    v_mfma_f32_16x16x32_bf16 v[144:147], v[108:111], v[100:103], v[144:147]
    ds_read_b64_tr_b16 v[66:67], v3 offset:5120
    v_mfma_f32_16x16x32_bf16 v[148:151], v[108:111], v[104:107], v[148:151]
    ds_read_b128 v[44:47], v2 offset:1024
    v_mfma_f32_16x16x32_bf16 v[152:155], v[112:115], v[84:87], v[152:155]
    ds_read_b128 v[48:51], v2 offset:2048
    v_mfma_f32_16x16x32_bf16 v[156:159], v[112:115], v[88:91], v[156:159]
    ds_read_b128 v[52:55], v2 offset:3072
    v_mfma_f32_16x16x32_bf16 v[160:163], v[112:115], v[92:95], v[160:163]
    ds_read_b128 v[56:59], v2 offset:4096
    v_mfma_f32_16x16x32_bf16 v[164:167], v[112:115], v[96:99], v[164:167]
    ds_read_b128 v[60:63], v2 offset:5120
    v_mfma_f32_16x16x32_bf16 v[168:171], v[112:115], v[100:103], v[168:171]
    ds_read_b64_tr_b16 v[68:69], v4 offset:32
    v_mfma_f32_16x16x32_bf16 v[172:175], v[112:115], v[104:107], v[172:175]
    ds_read_b64_tr_b16 v[70:71], v4 offset:5152
    v_mfma_f32_16x16x32_bf16 v[176:179], v[116:119], v[84:87], v[176:179]
    ds_read_b64_tr_b16 v[72:73], v3 offset:64
    v_mfma_f32_16x16x32_bf16 v[180:183], v[116:119], v[88:91], v[180:183]
    ds_read_b64_tr_b16 v[74:75], v3 offset:5184
    v_mfma_f32_16x16x32_bf16 v[184:187], v[116:119], v[92:95], v[184:187]
    ds_read_b64_tr_b16 v[76:77], v4 offset:96
    v_mfma_f32_16x16x32_bf16 v[188:191], v[116:119], v[96:99], v[188:191]
    ds_read_b64_tr_b16 v[78:79], v4 offset:5216
    v_mfma_f32_16x16x32_bf16 v[192:195], v[116:119], v[100:103], v[192:195]
    ds_read_b64_tr_b16 v[80:81], v3 offset:128
    v_mfma_f32_16x16x32_bf16 v[196:199], v[116:119], v[104:107], v[196:199]
    ds_read_b64_tr_b16 v[82:83], v3 offset:5248
    v_mfma_f32_16x16x32_bf16 v[200:203], v[120:123], v[84:87], v[200:203]
    v_mfma_f32_16x16x32_bf16 v[204:207], v[120:123], v[88:91], v[204:207]
    v_mfma_f32_16x16x32_bf16 v[208:211], v[120:123], v[92:95], v[208:211]
    v_mfma_f32_16x16x32_bf16 v[212:215], v[120:123], v[96:99], v[212:215]
    v_mfma_f32_16x16x32_bf16 v[216:219], v[120:123], v[100:103], v[216:219]
    v_mfma_f32_16x16x32_bf16 v[220:223], v[120:123], v[104:107], v[220:223]
    v_mfma_f32_16x16x32_bf16 v[224:227], v[124:127], v[84:87], v[224:227]
    v_mfma_f32_16x16x32_bf16 v[228:231], v[124:127], v[88:91], v[228:231]
    v_mfma_f32_16x16x32_bf16 v[232:235], v[124:127], v[92:95], v[232:235]
    v_mfma_f32_16x16x32_bf16 v[236:239], v[124:127], v[96:99], v[236:239]
    v_mfma_f32_16x16x32_bf16 v[240:243], v[124:127], v[100:103], v[240:243]
    v_mfma_f32_16x16x32_bf16 v[244:247], v[124:127], v[104:107], v[244:247]
    s_branch p2loop_68
p2out_69:
    s_waitcnt lgkmcnt(8)
    v_mfma_f32_16x16x32_bf16 v[128:131], v[108:111], v[84:87], v[128:131]
    v_mfma_f32_16x16x32_bf16 v[132:135], v[108:111], v[88:91], v[132:135]
    v_mfma_f32_16x16x32_bf16 v[136:139], v[108:111], v[92:95], v[136:139]
    v_mfma_f32_16x16x32_bf16 v[140:143], v[108:111], v[96:99], v[140:143]
    v_mfma_f32_16x16x32_bf16 v[144:147], v[108:111], v[100:103], v[144:147]
    v_mfma_f32_16x16x32_bf16 v[148:151], v[108:111], v[104:107], v[148:151]
    s_waitcnt lgkmcnt(6)
    v_mfma_f32_16x16x32_bf16 v[152:155], v[112:115], v[84:87], v[152:155]
    v_mfma_f32_16x16x32_bf16 v[156:159], v[112:115], v[88:91], v[156:159]
    v_mfma_f32_16x16x32_bf16 v[160:163], v[112:115], v[92:95], v[160:163]
    v_mfma_f32_16x16x32_bf16 v[164:167], v[112:115], v[96:99], v[164:167]
    v_mfma_f32_16x16x32_bf16 v[168:171], v[112:115], v[100:103], v[168:171]
    v_mfma_f32_16x16x32_bf16 v[172:175], v[112:115], v[104:107], v[172:175]
    s_waitcnt lgkmcnt(4)
    v_mfma_f32_16x16x32_bf16 v[176:179], v[116:119], v[84:87], v[176:179]
    v_mfma_f32_16x16x32_bf16 v[180:183], v[116:119], v[88:91], v[180:183]
    v_mfma_f32_16x16x32_bf16 v[184:187], v[116:119], v[92:95], v[184:187]
    v_mfma_f32_16x16x32_bf16 v[188:191], v[116:119], v[96:99], v[188:191]
    v_mfma_f32_16x16x32_bf16 v[192:195], v[116:119], v[100:103], v[192:195]
    v_mfma_f32_16x16x32_bf16 v[196:199], v[116:119], v[104:107], v[196:199]
    s_waitcnt lgkmcnt(2)
    v_mfma_f32_16x16x32_bf16 v[200:203], v[120:123], v[84:87], v[200:203]
    v_mfma_f32_16x16x32_bf16 v[204:207], v[120:123], v[88:91], v[204:207]
    v_mfma_f32_16x16x32_bf16 v[208:211], v[120:123], v[92:95], v[208:211]
    v_mfma_f32_16x16x32_bf16 v[212:215], v[120:123], v[96:99], v[212:215]
    v_mfma_f32_16x16x32_bf16 v[216:219], v[120:123], v[100:103], v[216:219]
    v_mfma_f32_16x16x32_bf16 v[220:223], v[120:123], v[104:107], v[220:223]
    s_waitcnt lgkmcnt(0)
    v_mfma_f32_16x16x32_bf16 v[224:227], v[124:127], v[84:87], v[224:227]
    v_mfma_f32_16x16x32_bf16 v[228:231], v[124:127], v[88:91], v[228:231]
    v_mfma_f32_16x16x32_bf16 v[232:235], v[124:127], v[92:95], v[232:235]
    v_mfma_f32_16x16x32_bf16 v[236:239], v[124:127], v[96:99], v[236:239]
    v_mfma_f32_16x16x32_bf16 v[240:243], v[124:127], v[100:103], v[240:243]
    v_mfma_f32_16x16x32_bf16 v[244:247], v[124:127], v[104:107], v[244:247]
    s_waitcnt lgkmcnt(0)
    v_mov_b32 v34, 18
    ds_write_b32 v32, v34
    v_add_u32 v25, 0, v10
    s_lshl_b32 s49, s3, 1
    s_add_u32 s49, s49, 0
    s_cmp_eq_u32 s49, s55
    s_cbranch_scc1 keep_70
    v_cvt_pk_bf16_f32 v40, v128, v129
    v_cvt_pk_bf16_f32 v41, v130, v131
    v_cvt_pk_bf16_f32 v42, v132, v133
    v_cvt_pk_bf16_f32 v43, v134, v135
    s_add_u32 s48, s62, 0
    buffer_store_dwordx4 v[40:43], v10, s[24:27], s48 offen offset:0 sc1
    v_cvt_pk_bf16_f32 v44, v136, v137
    v_cvt_pk_bf16_f32 v45, v138, v139
    v_cvt_pk_bf16_f32 v46, v152, v153
    v_cvt_pk_bf16_f32 v47, v154, v155
    buffer_store_dwordx4 v[44:47], v10, s[24:27], s48 offen offset:1024 sc1
    v_cvt_pk_bf16_f32 v48, v156, v157
    v_cvt_pk_bf16_f32 v49, v158, v159
    v_cvt_pk_bf16_f32 v50, v160, v161
    v_cvt_pk_bf16_f32 v51, v162, v163
    buffer_store_dwordx4 v[48:51], v10, s[24:27], s48 offen offset:2048 sc1
    v_cvt_pk_bf16_f32 v52, v176, v177
    v_cvt_pk_bf16_f32 v53, v178, v179
    v_cvt_pk_bf16_f32 v54, v180, v181
    v_cvt_pk_bf16_f32 v55, v182, v183
    buffer_store_dwordx4 v[52:55], v10, s[24:27], s48 offen offset:3072 sc1
    v_cvt_pk_bf16_f32 v56, v184, v185
    v_cvt_pk_bf16_f32 v57, v186, v187
    v_cvt_pk_bf16_f32 v58, v200, v201
    v_cvt_pk_bf16_f32 v59, v202, v203
    s_add_u32 s48, s62, 4096
    buffer_store_dwordx4 v[56:59], v10, s[24:27], s48 offen offset:0 sc1
    v_cvt_pk_bf16_f32 v60, v204, v205
    v_cvt_pk_bf16_f32 v61, v206, v207
    v_cvt_pk_bf16_f32 v62, v208, v209
    v_cvt_pk_bf16_f32 v63, v210, v211
    buffer_store_dwordx4 v[60:63], v10, s[24:27], s48 offen offset:1024 sc1
    v_cvt_pk_bf16_f32 v64, v224, v225
    v_cvt_pk_bf16_f32 v65, v226, v227
    v_cvt_pk_bf16_f32 v66, v228, v229
    v_cvt_pk_bf16_f32 v67, v230, v231
    buffer_store_dwordx4 v[64:67], v10, s[24:27], s48 offen offset:2048 sc1
    v_cvt_pk_bf16_f32 v68, v232, v233
    v_cvt_pk_bf16_f32 v69, v234, v235
    buffer_store_dwordx4 v[68:71], v10, s[24:27], s48 offen offset:3072 sc1
    s_branch sent_71
keep_70:
    v_cvt_pk_bf16_f32 v40, v128, v129
    v_cvt_pk_bf16_f32 v41, v130, v131
    v_cvt_pk_bf16_f32 v42, v132, v133
    v_cvt_pk_bf16_f32 v43, v134, v135
    v_cvt_pk_bf16_f32 v44, v136, v137
    v_cvt_pk_bf16_f32 v45, v138, v139
    v_cvt_pk_bf16_f32 v46, v152, v153
    v_cvt_pk_bf16_f32 v47, v154, v155
    v_cvt_pk_bf16_f32 v48, v156, v157
    v_cvt_pk_bf16_f32 v49, v158, v159
    v_cvt_pk_bf16_f32 v50, v160, v161
    v_cvt_pk_bf16_f32 v51, v162, v163
    v_cvt_pk_bf16_f32 v52, v176, v177
    v_cvt_pk_bf16_f32 v53, v178, v179
    v_cvt_pk_bf16_f32 v54, v180, v181
    v_cvt_pk_bf16_f32 v55, v182, v183
    v_cvt_pk_bf16_f32 v56, v184, v185
    v_cvt_pk_bf16_f32 v57, v186, v187
    v_cvt_pk_bf16_f32 v58, v200, v201
    v_cvt_pk_bf16_f32 v59, v202, v203
    v_cvt_pk_bf16_f32 v60, v204, v205
    v_cvt_pk_bf16_f32 v61, v206, v207
    v_cvt_pk_bf16_f32 v62, v208, v209
    v_cvt_pk_bf16_f32 v63, v210, v211
    v_cvt_pk_bf16_f32 v64, v224, v225
    v_cvt_pk_bf16_f32 v65, v226, v227
    v_cvt_pk_bf16_f32 v66, v228, v229
    v_cvt_pk_bf16_f32 v67, v230, v231
    v_cvt_pk_bf16_f32 v68, v232, v233
    v_cvt_pk_bf16_f32 v69, v234, v235
    s_mov_b32 s96, 0
lw_72:
    ds_read_b128 v[28:31], v33 offset:16
    s_add_u32 s96, s96, 1
    s_waitcnt lgkmcnt(0)
    v_min3_u32 v28, v28, v29, v30
    v_min_u32 v28, v28, v31
    s_nop 0
    v_readfirstlane_b32 s53, v28
    s_nop 0
    s_cmp_ge_u32 s53, 18
    s_cbranch_scc1 lwok_73
    s_cmp_lt_u32 s96, 2000000
    s_cbranch_scc1 lw_72
lwok_73:
    ds_write_b128 v25, v[40:43] offset:0
    ds_write_b128 v25, v[44:47] offset:1024
    ds_write_b128 v25, v[48:51] offset:2048
    ds_write_b128 v25, v[52:55] offset:3072
    ds_write_b128 v25, v[56:59] offset:4096
    ds_write_b128 v25, v[60:63] offset:5120
    ds_write_b128 v25, v[64:67] offset:6144
    ds_write_b128 v25, v[68:71] offset:7168
    v_mov_b32 v34, 2000
    ds_write_b32 v32, v34
sent_71:
    s_lshl_b32 s49, s3, 1
    s_add_u32 s49, s49, 1
    s_cmp_eq_u32 s49, s55
    s_cbranch_scc1 keep_74
    v_cvt_pk_bf16_f32 v72, v140, v141
    v_cvt_pk_bf16_f32 v73, v142, v143
    v_cvt_pk_bf16_f32 v74, v144, v145
    v_cvt_pk_bf16_f32 v75, v146, v147
    s_add_u32 s48, s62, 65536
    buffer_store_dwordx4 v[72:75], v10, s[24:27], s48 offen offset:0 sc1
    v_cvt_pk_bf16_f32 v76, v148, v149
    v_cvt_pk_bf16_f32 v77, v150, v151
    v_cvt_pk_bf16_f32 v78, v164, v165
    v_cvt_pk_bf16_f32 v79, v166, v167
    buffer_store_dwordx4 v[76:79], v10, s[24:27], s48 offen offset:1024 sc1
    v_cvt_pk_bf16_f32 v80, v168, v169
    v_cvt_pk_bf16_f32 v81, v170, v171
    v_cvt_pk_bf16_f32 v82, v172, v173
    v_cvt_pk_bf16_f32 v83, v174, v175
    buffer_store_dwordx4 v[80:83], v10, s[24:27], s48 offen offset:2048 sc1
    v_cvt_pk_bf16_f32 v84, v188, v189
    v_cvt_pk_bf16_f32 v85, v190, v191
    v_cvt_pk_bf16_f32 v86, v192, v193
    v_cvt_pk_bf16_f32 v87, v194, v195
    buffer_store_dwordx4 v[84:87], v10, s[24:27], s48 offen offset:3072 sc1
    v_cvt_pk_bf16_f32 v88, v196, v197
    v_cvt_pk_bf16_f32 v89, v198, v199
    v_cvt_pk_bf16_f32 v90, v212, v213
    v_cvt_pk_bf16_f32 v91, v214, v215
    s_add_u32 s48, s62, 69632
    buffer_store_dwordx4 v[88:91], v10, s[24:27], s48 offen offset:0 sc1
    v_cvt_pk_bf16_f32 v92, v216, v217
    v_cvt_pk_bf16_f32 v93, v218, v219
    v_cvt_pk_bf16_f32 v94, v220, v221
    v_cvt_pk_bf16_f32 v95, v222, v223
    buffer_store_dwordx4 v[92:95], v10, s[24:27], s48 offen offset:1024 sc1
    v_cvt_pk_bf16_f32 v96, v236, v237
    v_cvt_pk_bf16_f32 v97, v238, v239
    v_cvt_pk_bf16_f32 v98, v240, v241
    v_cvt_pk_bf16_f32 v99, v242, v243
    buffer_store_dwordx4 v[96:99], v10, s[24:27], s48 offen offset:2048 sc1
    v_cvt_pk_bf16_f32 v100, v244, v245
    v_cvt_pk_bf16_f32 v101, v246, v247
    buffer_store_dwordx4 v[100:103], v10, s[24:27], s48 offen offset:3072 sc1
    s_branch sent_75
keep_74:
    v_cvt_pk_bf16_f32 v72, v140, v141
    v_cvt_pk_bf16_f32 v73, v142, v143
    v_cvt_pk_bf16_f32 v74, v144, v145
    v_cvt_pk_bf16_f32 v75, v146, v147
    v_cvt_pk_bf16_f32 v76, v148, v149
    v_cvt_pk_bf16_f32 v77, v150, v151
    v_cvt_pk_bf16_f32 v78, v164, v165
    v_cvt_pk_bf16_f32 v79, v166, v167
    v_cvt_pk_bf16_f32 v80, v168, v169
    v_cvt_pk_bf16_f32 v81, v170, v171
    v_cvt_pk_bf16_f32 v82, v172, v173
    v_cvt_pk_bf16_f32 v83, v174, v175
    v_cvt_pk_bf16_f32 v84, v188, v189
    v_cvt_pk_bf16_f32 v85, v190, v191
    v_cvt_pk_bf16_f32 v86, v192, v193
    v_cvt_pk_bf16_f32 v87, v194, v195
    v_cvt_pk_bf16_f32 v88, v196, v197
    v_cvt_pk_bf16_f32 v89, v198, v199
    v_cvt_pk_bf16_f32 v90, v212, v213
    v_cvt_pk_bf16_f32 v91, v214, v215
    v_cvt_pk_bf16_f32 v92, v216, v217
    v_cvt_pk_bf16_f32 v93, v218, v219
    v_cvt_pk_bf16_f32 v94, v220, v221
    v_cvt_pk_bf16_f32 v95, v222, v223
    v_cvt_pk_bf16_f32 v96, v236, v237
    v_cvt_pk_bf16_f32 v97, v238, v239
    v_cvt_pk_bf16_f32 v98, v240, v241
    v_cvt_pk_bf16_f32 v99, v242, v243
    v_cvt_pk_bf16_f32 v100, v244, v245
    v_cvt_pk_bf16_f32 v101, v246, v247
    s_mov_b32 s96, 0
lw_76:
    ds_read_b128 v[28:31], v33 offset:16
    s_add_u32 s96, s96, 1
    s_waitcnt lgkmcnt(0)
    v_min3_u32 v28, v28, v29, v30
    v_min_u32 v28, v28, v31
    s_nop 0
    v_readfirstlane_b32 s53, v28
    s_nop 0
    s_cmp_ge_u32 s53, 18
    s_cbranch_scc1 lwok_77
    s_cmp_lt_u32 s96, 2000000
    s_cbranch_scc1 lw_76
lwok_77:
    ds_write_b128 v25, v[72:75] offset:0
    ds_write_b128 v25, v[76:79] offset:1024
    ds_write_b128 v25, v[80:83] offset:2048
    ds_write_b128 v25, v[84:87] offset:3072
    ds_write_b128 v25, v[88:91] offset:4096
    ds_write_b128 v25, v[92:95] offset:5120
    ds_write_b128 v25, v[96:99] offset:6144
    ds_write_b128 v25, v[100:103] offset:7168
    v_mov_b32 v34, 2000
    ds_write_b32 v32, v34
sent_75:
    s_mov_b64 exec, 3
    s_waitcnt vmcnt(0)
    buffer_store_dword v21, v22, s[24:27], s63 offen sc1
    s_mov_b64 exec, -1
    s_cmp_lg_u32 s3, 0
    s_cbranch_scc1 f2ok_79
    s_mov_b32 s96, 0
f2poll_78:
    buffer_load_dword v24, v23, s[24:27], s63 offen sc1
    s_waitcnt vmcnt(0)
    v_cmp_ne_u32 vcc, 0, v24
    s_add_u32 s96, s96, 1
    s_nop 2
    s_cmp_eq_u32 vcc_lo, -1
    s_cbranch_scc1 f2ok_79
    s_cmp_lt_u32 s96, 1000000
    s_cbranch_scc1 f2poll_78
f2ok_79:
    s_barrier
    s_add_u32 s48, s55, 1
    s_and_b32 s48, s48, 7
    s_lshl_b32 s48, s48, 13
    s_add_u32 s48, s48, s61
    buffer_load_dwordx4 v[136:139], v10, s[24:27], s48 offen offset:0 sc1
    buffer_load_dwordx4 v[140:143], v10, s[24:27], s48 offen offset:1024 sc1
    s_add_u32 s48, s55, 2
    s_and_b32 s48, s48, 7
    s_lshl_b32 s48, s48, 13
    s_add_u32 s48, s48, s61
    buffer_load_dwordx4 v[144:147], v10, s[24:27], s48 offen offset:0 sc1
    buffer_load_dwordx4 v[148:151], v10, s[24:27], s48 offen offset:1024 sc1
    s_add_u32 s48, s55, 3
    s_and_b32 s48, s48, 7
    s_lshl_b32 s48, s48, 13
    s_add_u32 s48, s48, s61
    buffer_load_dwordx4 v[152:155], v10, s[24:27], s48 offen offset:0 sc1
    buffer_load_dwordx4 v[156:159], v10, s[24:27], s48 offen offset:1024 sc1
    s_add_u32 s48, s55, 4
    s_and_b32 s48, s48, 7
    s_lshl_b32 s48, s48, 13
    s_add_u32 s48, s48, s61
    buffer_load_dwordx4 v[160:163], v10, s[24:27], s48 offen offset:0 sc1
    buffer_load_dwordx4 v[164:167], v10, s[24:27], s48 offen offset:1024 sc1
    s_add_u32 s48, s55, 5
    s_and_b32 s48, s48, 7
    s_lshl_b32 s48, s48, 13
    s_add_u32 s48, s48, s61
    buffer_load_dwordx4 v[168:171], v10, s[24:27], s48 offen offset:0 sc1
    buffer_load_dwordx4 v[172:175], v10, s[24:27], s48 offen offset:1024 sc1
    s_add_u32 s48, s55, 6
    s_and_b32 s48, s48, 7
    s_lshl_b32 s48, s48, 13
    s_add_u32 s48, s48, s61
    buffer_load_dwordx4 v[176:179], v10, s[24:27], s48 offen offset:0 sc1
    buffer_load_dwordx4 v[180:183], v10, s[24:27], s48 offen offset:1024 sc1
    s_add_u32 s48, s55, 7
    s_and_b32 s48, s48, 7
    s_lshl_b32 s48, s48, 13
    s_add_u32 s48, s48, s61
    buffer_load_dwordx4 v[184:187], v10, s[24:27], s48 offen offset:0 sc1
    buffer_load_dwordx4 v[188:191], v10, s[24:27], s48 offen offset:1024 sc1
    s_lshr_b32 s48, s55, 1
    s_lshl_b32 s48, s48, 2
    s_add_u32 s48, s48, 163344
    v_mov_b32 v26, s48
    s_lshl_b32 s48, s3, 11
    v_add_u32 v25, s48, v25
    s_mov_b32 s96, 0
ownw_80:
    ds_read_b32 v27, v26
    s_add_u32 s96, s96, 1
    s_waitcnt lgkmcnt(0)
    v_readfirstlane_b32 s53, v27
    s_nop 0
    s_cmp_ge_u32 s53, 2000
    s_cbranch_scc1 owngot_81
    s_cmp_lt_u32 s96, 2000000
    s_cbranch_scc1 ownw_80
owngot_81:
    ds_read_b128 v[128:131], v25 offset:0
    ds_read_b128 v[132:135], v25 offset:1024
    s_waitcnt lgkmcnt(0)
    v_lshlrev_b32 v200, 16, v128
    v_and_b32 v201, 0xffff0000, v128
    v_lshlrev_b32 v202, 16, v129
    v_and_b32 v203, 0xffff0000, v129
    v_lshlrev_b32 v204, 16, v130
    v_and_b32 v205, 0xffff0000, v130
    v_lshlrev_b32 v206, 16, v131
    v_and_b32 v207, 0xffff0000, v131
    v_lshlrev_b32 v208, 16, v132
    v_and_b32 v209, 0xffff0000, v132
    v_lshlrev_b32 v210, 16, v133
    v_and_b32 v211, 0xffff0000, v133
    v_lshlrev_b32 v212, 16, v134
    v_and_b32 v213, 0xffff0000, v134
    v_lshlrev_b32 v214, 16, v135
    v_and_b32 v215, 0xffff0000, v135
    s_waitcnt vmcnt(12)
    v_lshlrev_b32 v16, 16, v136
    v_and_b32 v17, 0xffff0000, v136
    v_add_f32 v200, v200, v16
    v_add_f32 v201, v201, v17
    v_lshlrev_b32 v16, 16, v137
    v_and_b32 v17, 0xffff0000, v137
    v_add_f32 v202, v202, v16
    v_add_f32 v203, v203, v17
    v_lshlrev_b32 v16, 16, v138
    v_and_b32 v17, 0xffff0000, v138
    v_add_f32 v204, v204, v16
    v_add_f32 v205, v205, v17
    v_lshlrev_b32 v16, 16, v139
    v_and_b32 v17, 0xffff0000, v139
    v_add_f32 v206, v206, v16
    v_add_f32 v207, v207, v17
    v_lshlrev_b32 v16, 16, v140
    v_and_b32 v17, 0xffff0000, v140
    v_add_f32 v208, v208, v16
    v_add_f32 v209, v209, v17
    v_lshlrev_b32 v16, 16, v141
    v_and_b32 v17, 0xffff0000, v141
    v_add_f32 v210, v210, v16
    v_add_f32 v211, v211, v17
    v_lshlrev_b32 v16, 16, v142
    v_and_b32 v17, 0xffff0000, v142
    v_add_f32 v212, v212, v16
    v_add_f32 v213, v213, v17
    v_lshlrev_b32 v16, 16, v143
    v_and_b32 v17, 0xffff0000, v143
    v_add_f32 v214, v214, v16
    v_add_f32 v215, v215, v17
    s_waitcnt vmcnt(10)
    v_lshlrev_b32 v16, 16, v144
    v_and_b32 v17, 0xffff0000, v144
    v_add_f32 v200, v200, v16
    v_add_f32 v201, v201, v17
    v_lshlrev_b32 v16, 16, v145
    v_and_b32 v17, 0xffff0000, v145
    v_add_f32 v202, v202, v16
    v_add_f32 v203, v203, v17
    v_lshlrev_b32 v16, 16, v146
    v_and_b32 v17, 0xffff0000, v146
    v_add_f32 v204, v204, v16
    v_add_f32 v205, v205, v17
    v_lshlrev_b32 v16, 16, v147
    v_and_b32 v17, 0xffff0000, v147
    v_add_f32 v206, v206, v16
    v_add_f32 v207, v207, v17
    v_lshlrev_b32 v16, 16, v148
    v_and_b32 v17, 0xffff0000, v148
    v_add_f32 v208, v208, v16
    v_add_f32 v209, v209, v17
    v_lshlrev_b32 v16, 16, v149
    v_and_b32 v17, 0xffff0000, v149
    v_add_f32 v210, v210, v16
    v_add_f32 v211, v211, v17
    v_lshlrev_b32 v16, 16, v150
    v_and_b32 v17, 0xffff0000, v150
    v_add_f32 v212, v212, v16
    v_add_f32 v213, v213, v17
    v_lshlrev_b32 v16, 16, v151
    v_and_b32 v17, 0xffff0000, v151
    v_add_f32 v214, v214, v16
    v_add_f32 v215, v215, v17
    s_waitcnt vmcnt(8)
    v_lshlrev_b32 v16, 16, v152
    v_and_b32 v17, 0xffff0000, v152
    v_add_f32 v200, v200, v16
    v_add_f32 v201, v201, v17
    v_lshlrev_b32 v16, 16, v153
    v_and_b32 v17, 0xffff0000, v153
    v_add_f32 v202, v202, v16
    v_add_f32 v203, v203, v17
    v_lshlrev_b32 v16, 16, v154
    v_and_b32 v17, 0xffff0000, v154
    v_add_f32 v204, v204, v16
    v_add_f32 v205, v205, v17
    v_lshlrev_b32 v16, 16, v155
    v_and_b32 v17, 0xffff0000, v155
    v_add_f32 v206, v206, v16
    v_add_f32 v207, v207, v17
    v_lshlrev_b32 v16, 16, v156
    v_and_b32 v17, 0xffff0000, v156
    v_add_f32 v208, v208, v16
    v_add_f32 v209, v209, v17
    v_lshlrev_b32 v16, 16, v157
    v_and_b32 v17, 0xffff0000, v157
    v_add_f32 v210, v210, v16
    v_add_f32 v211, v211, v17
    v_lshlrev_b32 v16, 16, v158
    v_and_b32 v17, 0xffff0000, v158
    v_add_f32 v212, v212, v16
    v_add_f32 v213, v213, v17
    v_lshlrev_b32 v16, 16, v159
    v_and_b32 v17, 0xffff0000, v159
    v_add_f32 v214, v214, v16
    v_add_f32 v215, v215, v17
    s_waitcnt vmcnt(6)
    v_lshlrev_b32 v16, 16, v160
    v_and_b32 v17, 0xffff0000, v160
    v_add_f32 v200, v200, v16
    v_add_f32 v201, v201, v17
    v_lshlrev_b32 v16, 16, v161
    v_and_b32 v17, 0xffff0000, v161
    v_add_f32 v202, v202, v16
    v_add_f32 v203, v203, v17
    v_lshlrev_b32 v16, 16, v162
    v_and_b32 v17, 0xffff0000, v162
    v_add_f32 v204, v204, v16
    v_add_f32 v205, v205, v17
    v_lshlrev_b32 v16, 16, v163
    v_and_b32 v17, 0xffff0000, v163
    v_add_f32 v206, v206, v16
    v_add_f32 v207, v207, v17
    v_lshlrev_b32 v16, 16, v164
    v_and_b32 v17, 0xffff0000, v164
    v_add_f32 v208, v208, v16
    v_add_f32 v209, v209, v17
    v_lshlrev_b32 v16, 16, v165
    v_and_b32 v17, 0xffff0000, v165
    v_add_f32 v210, v210, v16
    v_add_f32 v211, v211, v17
    v_lshlrev_b32 v16, 16, v166
    v_and_b32 v17, 0xffff0000, v166
    v_add_f32 v212, v212, v16
    v_add_f32 v213, v213, v17
    v_lshlrev_b32 v16, 16, v167
    v_and_b32 v17, 0xffff0000, v167
    v_add_f32 v214, v214, v16
    v_add_f32 v215, v215, v17
    s_waitcnt vmcnt(4)
    v_lshlrev_b32 v16, 16, v168
    v_and_b32 v17, 0xffff0000, v168
    v_add_f32 v200, v200, v16
    v_add_f32 v201, v201, v17
    v_lshlrev_b32 v16, 16, v169
    v_and_b32 v17, 0xffff0000, v169
    v_add_f32 v202, v202, v16
    v_add_f32 v203, v203, v17
    v_lshlrev_b32 v16, 16, v170
    v_and_b32 v17, 0xffff0000, v170
    v_add_f32 v204, v204, v16
    v_add_f32 v205, v205, v17
    v_lshlrev_b32 v16, 16, v171
    v_and_b32 v17, 0xffff0000, v171
    v_add_f32 v206, v206, v16
    v_add_f32 v207, v207, v17
    v_lshlrev_b32 v16, 16, v172
    v_and_b32 v17, 0xffff0000, v172
    v_add_f32 v208, v208, v16
    v_add_f32 v209, v209, v17
    v_lshlrev_b32 v16, 16, v173
    v_and_b32 v17, 0xffff0000, v173
    v_add_f32 v210, v210, v16
    v_add_f32 v211, v211, v17
    v_lshlrev_b32 v16, 16, v174
    v_and_b32 v17, 0xffff0000, v174
    v_add_f32 v212, v212, v16
    v_add_f32 v213, v213, v17
    v_lshlrev_b32 v16, 16, v175
    v_and_b32 v17, 0xffff0000, v175
    v_add_f32 v214, v214, v16
    v_add_f32 v215, v215, v17
    s_waitcnt vmcnt(2)
    v_lshlrev_b32 v16, 16, v176
    v_and_b32 v17, 0xffff0000, v176
    v_add_f32 v200, v200, v16
    v_add_f32 v201, v201, v17
    v_lshlrev_b32 v16, 16, v177
    v_and_b32 v17, 0xffff0000, v177
    v_add_f32 v202, v202, v16
    v_add_f32 v203, v203, v17
    v_lshlrev_b32 v16, 16, v178
    v_and_b32 v17, 0xffff0000, v178
    v_add_f32 v204, v204, v16
    v_add_f32 v205, v205, v17
    v_lshlrev_b32 v16, 16, v179
    v_and_b32 v17, 0xffff0000, v179
    v_add_f32 v206, v206, v16
    v_add_f32 v207, v207, v17
    v_lshlrev_b32 v16, 16, v180
    v_and_b32 v17, 0xffff0000, v180
    v_add_f32 v208, v208, v16
    v_add_f32 v209, v209, v17
    v_lshlrev_b32 v16, 16, v181
    v_and_b32 v17, 0xffff0000, v181
    v_add_f32 v210, v210, v16
    v_add_f32 v211, v211, v17
    v_lshlrev_b32 v16, 16, v182
    v_and_b32 v17, 0xffff0000, v182
    v_add_f32 v212, v212, v16
    v_add_f32 v213, v213, v17
    v_lshlrev_b32 v16, 16, v183
    v_and_b32 v17, 0xffff0000, v183
    v_add_f32 v214, v214, v16
    v_add_f32 v215, v215, v17
    s_waitcnt vmcnt(0)
    v_lshlrev_b32 v16, 16, v184
    v_and_b32 v17, 0xffff0000, v184
    v_add_f32 v200, v200, v16
    v_add_f32 v201, v201, v17
    v_lshlrev_b32 v16, 16, v185
    v_and_b32 v17, 0xffff0000, v185
    v_add_f32 v202, v202, v16
    v_add_f32 v203, v203, v17
    v_lshlrev_b32 v16, 16, v186
    v_and_b32 v17, 0xffff0000, v186
    v_add_f32 v204, v204, v16
    v_add_f32 v205, v205, v17
    v_lshlrev_b32 v16, 16, v187
    v_and_b32 v17, 0xffff0000, v187
    v_add_f32 v206, v206, v16
    v_add_f32 v207, v207, v17
    v_lshlrev_b32 v16, 16, v188
    v_and_b32 v17, 0xffff0000, v188
    v_add_f32 v208, v208, v16
    v_add_f32 v209, v209, v17
    v_lshlrev_b32 v16, 16, v189
    v_and_b32 v17, 0xffff0000, v189
    v_add_f32 v210, v210, v16
    v_add_f32 v211, v211, v17
    v_lshlrev_b32 v16, 16, v190
    v_and_b32 v17, 0xffff0000, v190
    v_add_f32 v212, v212, v16
    v_add_f32 v213, v213, v17
    v_lshlrev_b32 v16, 16, v191
    v_and_b32 v17, 0xffff0000, v191
    v_add_f32 v214, v214, v16
    v_add_f32 v215, v215, v17
    v_cvt_pk_bf16_f32 v40, v200, v201
    v_cvt_pk_bf16_f32 v41, v202, v203
    buffer_store_dwordx2 v[40:41], v9, s[32:35], s59 offen
    v_cvt_pk_bf16_f32 v42, v204, v205
    v_cvt_pk_bf16_f32 v43, v206, v207
    buffer_store_dwordx2 v[42:43], v9, s[32:35], s60 offen
    v_cvt_pk_bf16_f32 v44, v208, v209
    v_cvt_pk_bf16_f32 v45, v210, v211
    buffer_store_dwordx2 v[44:45], v9, s[32:35], s56 offen
    v_cvt_pk_bf16_f32 v46, v212, v213
    v_cvt_pk_bf16_f32 v47, v214, v215
    buffer_store_dwordx2 v[46:47], v9, s[32:35], s97 offen
    s_endpgm
spin_54:
    s_mov_b32 s96, 0
lw_82:
    ds_read_b128 v[28:31], v33 offset:0
    s_add_u32 s96, s96, 1
    s_waitcnt lgkmcnt(0)
    v_min3_u32 v28, v28, v29, v30
    v_min_u32 v28, v28, v31
    s_nop 0
    v_readfirstlane_b32 s53, v28
    s_nop 0
    s_cmp_ge_u32 s53, 13
    s_cbranch_scc1 ret_55
    s_cmp_lt_u32 s96, 2000000
    s_cbranch_scc1 lw_82
    s_branch ret_55
spin_56:
    s_mov_b32 s96, 0
lw_84:
    ds_read_b128 v[28:31], v33 offset:16
    s_add_u32 s96, s96, 1
    s_waitcnt lgkmcnt(0)
    v_min3_u32 v28, v28, v29, v30
    v_min_u32 v28, v28, v31
    s_nop 0
    v_readfirstlane_b32 s53, v28
    s_nop 0
    s_cmp_ge_u32 s53, 12
    s_cbranch_scc1 ret_57
    s_cmp_lt_u32 s96, 2000000
    s_cbranch_scc1 lw_84
    s_branch ret_57
spin_58:
    s_mov_b32 s96, 0
lw_86:
    ds_read_b128 v[28:31], v33 offset:0
    s_add_u32 s96, s96, 1
    s_waitcnt lgkmcnt(0)
    v_min3_u32 v28, v28, v29, v30
    v_min_u32 v28, v28, v31
    s_nop 0
    v_readfirstlane_b32 s53, v28
    s_nop 0
    s_cmp_ge_u32 s53, 14
    s_cbranch_scc1 ret_59
    s_cmp_lt_u32 s96, 2000000
    s_cbranch_scc1 lw_86
    s_branch ret_59
spin_60:
    s_mov_b32 s96, 0
lw_88:
    ds_read_b128 v[28:31], v33 offset:16
    s_add_u32 s96, s96, 1
    s_waitcnt lgkmcnt(0)
    v_min3_u32 v28, v28, v29, v30
    v_min_u32 v28, v28, v31
    s_nop 0
    v_readfirstlane_b32 s53, v28
    s_nop 0
    s_cmp_ge_u32 s53, 13
    s_cbranch_scc1 ret_61
    s_cmp_lt_u32 s96, 2000000
    s_cbranch_scc1 lw_88
    s_branch ret_61
spin_62:
    s_mov_b32 s96, 0
lw_90:
    ds_read_b128 v[28:31], v33 offset:16
    s_add_u32 s96, s96, 1
    s_waitcnt lgkmcnt(0)
    v_min3_u32 v28, v28, v29, v30
    v_min_u32 v28, v28, v31
    s_nop 0
    v_readfirstlane_b32 s53, v28
    s_nop 0
    s_cmp_ge_u32 s53, 15
    s_cbranch_scc1 ret_63
    s_cmp_lt_u32 s96, 2000000
    s_cbranch_scc1 lw_90
    s_branch ret_63
kend_1:
TAIL_END:
    s_endpgm
.section .rodata,"a"
.p2align 6
.amdhsa_kernel concat_heads__gqa_block_cached__gqa_block_cached__near_ridge_kernel
  .amdhsa_next_free_vgpr 256
  .amdhsa_next_free_sgpr 102
  .amdhsa_accum_offset 256
  .amdhsa_group_segment_fixed_size 0
  .amdhsa_kernarg_size 104
  .amdhsa_user_sgpr_count 2
  .amdhsa_user_sgpr_kernarg_segment_ptr 1
  .amdhsa_system_sgpr_workgroup_id_x 1
  .amdhsa_float_denorm_mode_32 3
.end_amdhsa_kernel
```
